```python
import torch

def _softmax(x, axis=-1):
    return torch.softmax(x, dim=axis)

def _gelu(x):
    return torch.nn.functional.gelu(x, approximate='tanh')

def _silu(x):
    return torch.nn.functional.silu(x)

def _sigmoid(x):
    return torch.sigmoid(x)

def _layernorm(x, axis=-1, eps=1e-05):
    m = x.mean(dim=axis, keepdim=True)
    v = x.var(dim=axis, keepdim=True, unbiased=False)
    return (x - m) / torch.sqrt(v + eps)

def _scatter_add(tgt, idx, src, axis=0):
    return tgt.clone().index_add_(axis, idx, src)

def _segment_sum(src, seg, n):
    out = torch.zeros((n,) + src.shape[1:], dtype=src.dtype)
    return out.index_add_(0, seg, src)

def _pad(x, pw):
    flat = tuple((v for pair in reversed(pw) for v in pair))
    return torch.nn.functional.pad(x, flat)
kernel_name = 'adaLN_cond__sliding_block_cached__dense_activation_relu__decode'

def setup_inputs():

    _w = lambda a: (lambda t: t.to(torch.bfloat16) if t.is_floating_point() else t)(torch.as_tensor(a))

    def _A_setup():
        B, Sq, D = (1, 1, 640)
        Hq, Hkv, Sk, Dh = (32, 32, 16384, 128)
        assert Hq % Hkv == 0, (Hq, Hkv)
        return {'x': _w((lambda *s: torch.randn(*s, dtype=torch.bfloat16) * 0.05)(B, Sq, D)), 'k_cache': _w((lambda *s: torch.randn(*s, dtype=torch.bfloat16) * 3.2)(B, Hkv, Sk, Dh)), 'v_cache': _w((lambda *s: torch.randn(*s, dtype=torch.bfloat16) * 0.4)(B, Hkv, Sk, Dh)), 'wq': _w((lambda *s: torch.randn(*s, dtype=torch.bfloat16) * 3.2)(D, Hq * Dh) * D ** (-0.5)), 'wo': _w((lambda *s: torch.randn(*s, dtype=torch.bfloat16) * 0.4)(Hq * Dh, D) * (Hq * Dh) ** (-0.5))}
    _A_in = _A_setup()

    def _B_setup():
        B, S, D, Dff = (1, 1, 640, 1728)
        return {'x': _w((lambda *s: torch.randn(*s, dtype=torch.bfloat16) * 0.05)(B, S, D)), 'w1': _w((lambda *s: torch.randn(*s, dtype=torch.bfloat16) * 0.05)(D, Dff)), 'w2': _w((lambda *s: torch.randn(*s, dtype=torch.bfloat16) * 0.05)(Dff, D))}
    _B_in = _B_setup()
    return {'A_x': _A_in['x'], 'A_k_cache': _A_in['k_cache'], 'A_v_cache': _A_in['v_cache'], 'A_wq': _A_in['wq'], 'A_wo': _A_in['wo'], 'B_x': _B_in['x'], 'B_w1': _B_in['w1'], 'B_w2': _B_in['w2'], 'c': _w((lambda *s: torch.randn(*s, dtype=torch.bfloat16) * 0.1)(1, 640) * 8.0), 'w_mod': _w((lambda *s: torch.randn(*s, dtype=torch.bfloat16) * 0.1)(640, 6 * 640) * 640 ** (-0.5) * 8.0)}

def reference(A_x, A_k_cache, A_v_cache, A_wq, A_wo, B_x, B_w1, B_w2, c, w_mod):

    def _A_ref(x, k_cache, v_cache, wq, wo):
        B, Sq, D = x.shape
        Hq, Dh = (32, 128)
        Hkv, Sk = (k_cache.shape[1], k_cache.shape[2])
        W = min(4096, max(256, Sk // 4))
        rep = Hq // Hkv
        q = (lambda x, *d: x.permute(*d))((x @ wq).reshape(B, Sq, Hq, Dh), 0, 2, 1, 3)
        k = (lambda x, n, axis: torch.repeat_interleave(x, n, dim=axis))(k_cache[:, :, Sk - W:, :], rep, axis=1)
        v = (lambda x, n, axis: torch.repeat_interleave(x, n, dim=axis))(v_cache[:, :, Sk - W:, :], rep, axis=1)
        scores = torch.einsum('bhqd,bhkd->bhqk', q, k) * Dh ** (-0.5)
        p = _softmax(scores, axis=-1)
        o = torch.einsum('bhqk,bhkd->bhqd', p, v)
        return (lambda x, *d: x.permute(*d))(o, 0, 2, 1, 3).reshape(B, Sq, Hq * Dh) @ wo

    def _B_ref(x, w1, w2):
        h = torch.einsum('bsd,df->bsf', x, w1)
        zero = torch.zeros_like(h)
        h = torch.maximum(h, zero)
        return torch.einsum('bsf,fd->bsd', h, w2)
    x = A_x
    mod = (_silu(c) @ w_mod).reshape(c.shape[0], 6, 1, -1)
    sa, ca, ga, sb, cb, gb = (mod[:, 0].clone(), mod[:, 1].clone(), mod[:, 2].clone(), mod[:, 3].clone(), mod[:, 4].clone(), mod[:, 5].clone())
    h = _layernorm(x, axis=-1) * (1 + ca) + sa
    x = x + ga * _A_ref(h, A_k_cache, A_v_cache, A_wq, A_wo)
    h = _layernorm(x, axis=-1) * (1 + cb) + sb
    x = x + gb * _B_ref(h, B_w1, B_w2)
    return x
```

```asm
; @launch grid=(256,1,1) block=(1024,1,1) lds=148480
.amdgcn_target "amdgcn-amd-amdhsa--gfx950"
.text
.globl adaLN_cond__sliding_block_cached__dense_activation_relu__decode_kernel
.p2align 8
.type adaLN_cond__sliding_block_cached__dense_activation_relu__decode_kernel,@function
adaLN_cond__sliding_block_cached__dense_activation_relu__decode_kernel:
    s_cmp_ge_u32 s2, 256
    s_cbranch_scc1 L_end2
    s_load_dwordx16 s[36:51], s[0:1], 0
    s_load_dwordx8 s[52:59], s[0:1], 64
    s_load_dwordx2 s[16:17], s[0:1], 96
    s_load_dwordx2 s[18:19], s[0:1], 88
    v_lshrrev_b32 v1, 6, v0
    v_and_b32 v0, 63, v0
    s_nop 0
    v_readfirstlane_b32 s3, v1
    s_and_b32 s4, s2, 7
    s_lshl_b32 s4, s4, 2
    s_lshr_b32 s6, s2, 3
    s_and_b32 s6, s6, 3
    s_add_u32 s4, s4, s6
    s_lshr_b32 s5, s2, 5
    s_mov_b32 s35, 0
    s_cmp_lg_u32 s3, 9
    s_cbranch_scc1 L_noinit
    v_lshlrev_b32 v2, 2, v0
    v_add_u32 v2, 131072, v2
    v_mov_b32 v3, 0
    ds_write_b32 v2, v3
L_noinit:
    s_lshl_b32 s9, s4, 22
    s_add_u32 s9, s9, 0x300000
    s_lshl_b32 s6, s5, 17
    s_add_u32 s9, s9, s6
    s_lshl_b32 s10, s4, 3
    s_add_u32 s10, s10, s5
    s_waitcnt lgkmcnt(0)
    s_cmp_ge_u32 s3, 8
    s_cbranch_scc1 L_vwave
    s_cmp_eq_u32 s2, 0
    s_cbranch_scc1 L_clear_early
    s_sub_u32 s11, s2, 170
    s_cmp_lt_u32 s11, 32
    s_cbranch_scc1 L_clear_late
    s_sub_u32 s11, s2, 81
    s_cmp_lt_u32 s11, 64
    s_cbranch_scc1 L_p2
L_roles:
    s_cmp_le_u32 s3, 1
    s_cbranch_scc1 L_p1
    s_cmp_eq_u32 s3, 6
    s_cbranch_scc1 L_flags
L_roles2:
    s_cmp_eq_u32 s3, 7
    s_cbranch_scc1 L_qget
    s_branch L_qk
L_clear_early:
    s_setprio 3
    v_mov_b32 v4, -1
    v_mov_b32 v5, -1
    v_mov_b32 v6, -1
    v_mov_b32 v7, -1
    s_mul_i32 s6, s3, 3584
    v_lshlrev_b32 v2, 4, v0
    v_add_u32 v2, s6, v2
    global_store_dwordx4 v2, v[4:7], s[16:17] offset:0 sc1
    global_store_dwordx4 v2, v[4:7], s[16:17] offset:1024 sc1
    global_store_dwordx4 v2, v[4:7], s[16:17] offset:2048 sc1
    s_mov_b32 exec_lo, -1
    s_mov_b32 exec_hi, 0
    global_store_dwordx4 v2, v[4:7], s[16:17] offset:3072 sc1
    s_mov_b64 exec, -1
    s_mov_b32 s12, 0
    s_branch L_clear_fin
L_clear_late:
    s_setprio 3
    v_mov_b32 v4, -1
    v_mov_b32 v5, -1
    v_mov_b32 v6, -1
    v_mov_b32 v7, -1
    s_mul_i32 s6, s11, 11264
    s_add_u32 s6, s6, 28672
    s_mul_i32 s8, s3, 1408
    s_add_u32 s6, s6, s8
    v_lshlrev_b32 v2, 4, v0
    v_add_u32 v2, s6, v2
    global_store_dwordx4 v2, v[4:7], s[16:17] sc1
    s_mov_b64 exec, 0xffffff
    global_store_dwordx4 v2, v[4:7], s[16:17] offset:1024 sc1
    s_mov_b64 exec, -1
    s_lshl_b32 s12, s11, 2
    s_add_u32 s12, s12, 128
L_clear_fin:
    s_cmp_lg_u32 s35, 0
    s_cbranch_scc1 BO_1
    s_barrier
    s_mov_b32 s35, 1
BO_1:
    s_waitcnt vmcnt(0)
    s_mov_b64 exec, 1
    s_waitcnt lgkmcnt(0)
    v_mov_b32 v118, 131152
    v_mov_b32 v119, 1
    ds_add_rtn_u32 v119, v118, v119
    s_waitcnt lgkmcnt(0)
    v_readfirstlane_b32 s6, v119
    s_mov_b64 exec, -1
    s_setprio 0
    s_cmp_lg_u32 s6, 7
    s_cbranch_scc1 L_roles
    v_mov_b32 v2, s12
    v_mov_b32 v3, 1
    s_mov_b64 exec, 1
    global_store_dword v2, v3, s[18:19] sc1
    s_mov_b64 exec, -1
    s_branch L_roles
L_flags:
    s_cmp_lg_u32 s35, 0
    s_cbranch_scc1 BO_2
    s_barrier
    s_mov_b32 s35, 1
BO_2:
    s_cmp_eq_u32 s2, 0
    s_cbranch_scc1 L_flags_agg
    s_cmp_ge_u32 s2, 145
    s_cbranch_scc1 L_flags_s
    v_mov_b32 v122, 0
    s_mov_b32 s7, 400000
S0_3:
    global_load_dword v123, v122, s[18:19] sc1
    s_waitcnt vmcnt(0)
    v_cmp_ne_u32 vcc, 1, v123
    s_nop 0
    s_cbranch_vccz S0D_4
    s_sleep 2
    s_sub_u32 s7, s7, 1
    s_cmp_lg_u32 s7, 0
    s_cbranch_scc1 S0_3
S0D_4:
    s_waitcnt lgkmcnt(0)
    v_mov_b32 v118, 131148
    v_mov_b32 v119, 1
    ds_write_b32 v118, v119
L_flags_s:
    v_mov_b32 v118, 131100
    s_mov_b32 s7, 3200000
LW_5:
    ds_read_b32 v119, v118
    s_waitcnt lgkmcnt(0)
    v_readfirstlane_b32 s6, v119
    s_nop 0
    s_cmp_ge_u32 s6, 1
    s_cbranch_scc1 LWD_6
    s_sleep 4
    s_sub_u32 s7, s7, 1
    s_cmp_lg_u32 s7, 0
    s_cbranch_scc1 LW_5
LWD_6:
    v_mov_b32 v122, 4
    s_mov_b32 s7, 400000
S0_7:
    global_load_dword v123, v122, s[18:19] sc1
    s_waitcnt vmcnt(0)
    v_cmp_ne_u32 vcc, 1, v123
    s_nop 0
    s_cbranch_vccz S0D_8
    s_sleep 16
    s_sub_u32 s7, s7, 1
    s_cmp_lg_u32 s7, 0
    s_cbranch_scc1 S0_7
S0D_8:
    s_waitcnt lgkmcnt(0)
    v_mov_b32 v118, 131096
    v_mov_b32 v119, 1
    ds_write_b32 v118, v119
    s_waitcnt lgkmcnt(0)
    v_mov_b32 v118, 131148
    v_mov_b32 v119, 1
    ds_write_b32 v118, v119
L_flags_x:
    s_cmp_ge_u32 s3, 8
    s_cbranch_scc1 L_vw2
    s_branch L_qk
L_flags_agg:
    v_mov_b32 v118, 131152
    s_mov_b32 s7, 3200000
LW_9:
    ds_read_b32 v119, v118
    s_waitcnt lgkmcnt(0)
    v_readfirstlane_b32 s6, v119
    s_nop 0
    s_cmp_ge_u32 s6, 8
    s_cbranch_scc1 LWD_10
    s_sleep 1
    s_sub_u32 s7, s7, 1
    s_cmp_lg_u32 s7, 0
    s_cbranch_scc1 LW_9
LWD_10:
    s_waitcnt lgkmcnt(0)
    v_mov_b32 v118, 131148
    v_mov_b32 v119, 1
    ds_write_b32 v118, v119
    s_mov_b32 s7, 400000
L_agg:
    s_load_dwordx16 s[64:79], s[18:19], 128 glc
    s_load_dwordx16 s[80:95], s[18:19], 192 glc
    s_waitcnt lgkmcnt(0)
    s_and_b32 s6, s64, s65
    s_and_b32 s6, s6, s66
    s_and_b32 s6, s6, s67
    s_and_b32 s6, s6, s68
    s_and_b32 s6, s6, s69
    s_and_b32 s6, s6, s70
    s_and_b32 s6, s6, s71
    s_and_b32 s6, s6, s72
    s_and_b32 s6, s6, s73
    s_and_b32 s6, s6, s74
    s_and_b32 s6, s6, s75
    s_and_b32 s6, s6, s76
    s_and_b32 s6, s6, s77
    s_and_b32 s6, s6, s78
    s_and_b32 s6, s6, s79
    s_and_b32 s6, s6, s80
    s_and_b32 s6, s6, s81
    s_and_b32 s6, s6, s82
    s_and_b32 s6, s6, s83
    s_and_b32 s6, s6, s84
    s_and_b32 s6, s6, s85
    s_and_b32 s6, s6, s86
    s_and_b32 s6, s6, s87
    s_and_b32 s6, s6, s88
    s_and_b32 s6, s6, s89
    s_and_b32 s6, s6, s90
    s_and_b32 s6, s6, s91
    s_and_b32 s6, s6, s92
    s_and_b32 s6, s6, s93
    s_and_b32 s6, s6, s94
    s_and_b32 s6, s6, s95
    s_cmp_eq_u32 s6, 1
    s_cbranch_scc1 L_agg_d
    s_sleep 4
    s_sub_u32 s7, s7, 1
    s_cmp_lg_u32 s7, 0
    s_cbranch_scc1 L_agg
L_agg_d:
    v_mov_b32 v2, 4
    v_mov_b32 v3, 1
    s_mov_b64 exec, 1
    global_store_dword v2, v3, s[18:19] sc1
    s_mov_b64 exec, -1
    s_waitcnt lgkmcnt(0)
    v_mov_b32 v118, 131096
    v_mov_b32 v119, 1
    ds_write_b32 v118, v119
    s_branch L_qk
L_kload:
    s_setprio 2
    s_mov_b32 s20, s38
    s_and_b32 s21, s39, 0xffff
    s_mov_b32 s22, 134217728
    s_mov_b32 s23, 0x20000
    v_lshrrev_b32 v6, 4, v0
    v_and_b32 v7, 15, v0
    v_add_u32 v8, 0, v6
    v_xor_b32 v8, v8, v7
    v_lshlrev_b32 v8, 4, v8
    v_lshl_add_u32 v2, v6, 8, v8
    v_add_u32 v8, 4, v6
    v_xor_b32 v8, v8, v7
    v_lshlrev_b32 v8, 4, v8
    v_lshl_add_u32 v3, v6, 8, v8
    v_add_u32 v8, 8, v6
    v_xor_b32 v8, v8, v7
    v_lshlrev_b32 v8, 4, v8
    v_lshl_add_u32 v4, v6, 8, v8
    v_add_u32 v8, 12, v6
    v_xor_b32 v8, v8, v7
    v_lshlrev_b32 v8, 4, v8
    v_lshl_add_u32 v5, v6, 8, v8
    s_mov_b32 s8, s9
    s_mov_b32 s11, 0
    s_cmp_lt_u32 s2, 145
    s_cbranch_scc1 L_kl_gate
    s_sub_u32 s12, s2, 170
    s_cmp_lt_u32 s12, 32
    s_cbranch_scc1 L_kl_gate
    s_mov_b32 m0, s11
    s_nop 0
    buffer_load_dwordx4 v2, s[20:23], s8 offen offset:0 nt lds
    buffer_load_dwordx4 v3, s[20:23], s8 offen offset:1024 nt lds
    buffer_load_dwordx4 v4, s[20:23], s8 offen offset:2048 nt lds
    buffer_load_dwordx4 v5, s[20:23], s8 offen offset:3072 nt lds
    s_add_u32 s8, s8, 4096
    s_add_u32 s11, s11, 4096
    s_mov_b32 m0, s11
    s_nop 0
    buffer_load_dwordx4 v2, s[20:23], s8 offen offset:0 nt lds
    buffer_load_dwordx4 v3, s[20:23], s8 offen offset:1024 nt lds
    buffer_load_dwordx4 v4, s[20:23], s8 offen offset:2048 nt lds
    buffer_load_dwordx4 v5, s[20:23], s8 offen offset:3072 nt lds
    s_add_u32 s8, s8, 4096
    s_add_u32 s11, s11, 4096
    s_mov_b32 m0, s11
    s_nop 0
    buffer_load_dwordx4 v2, s[20:23], s8 offen offset:0 nt lds
    buffer_load_dwordx4 v3, s[20:23], s8 offen offset:1024 nt lds
    buffer_load_dwordx4 v4, s[20:23], s8 offen offset:2048 nt lds
    buffer_load_dwordx4 v5, s[20:23], s8 offen offset:3072 nt lds
    s_add_u32 s8, s8, 4096
    s_add_u32 s11, s11, 4096
    s_mov_b32 m0, s11
    s_nop 0
    buffer_load_dwordx4 v2, s[20:23], s8 offen offset:0 nt lds
    buffer_load_dwordx4 v3, s[20:23], s8 offen offset:1024 nt lds
    buffer_load_dwordx4 v4, s[20:23], s8 offen offset:2048 nt lds
    buffer_load_dwordx4 v5, s[20:23], s8 offen offset:3072 nt lds
    s_add_u32 s8, s8, 4096
    s_add_u32 s11, s11, 4096
    s_mov_b32 m0, s11
    s_nop 0
    buffer_load_dwordx4 v2, s[20:23], s8 offen offset:0 nt lds
    buffer_load_dwordx4 v3, s[20:23], s8 offen offset:1024 nt lds
    buffer_load_dwordx4 v4, s[20:23], s8 offen offset:2048 nt lds
    buffer_load_dwordx4 v5, s[20:23], s8 offen offset:3072 nt lds
    s_add_u32 s8, s8, 4096
    s_add_u32 s11, s11, 4096
    s_cmp_lg_u32 s35, 0
    s_cbranch_scc1 BO_11
    s_barrier
    s_mov_b32 s35, 1
BO_11:
    s_branch L_klo_0
L_kl_gate:
    s_cmp_lg_u32 s35, 0
    s_cbranch_scc1 BO_12
    s_barrier
    s_mov_b32 s35, 1
BO_12:
    v_mov_b32 v118, 131144
    s_mov_b32 s7, 3200000
LW_13:
    ds_read_b32 v119, v118
    s_waitcnt lgkmcnt(0)
    v_readfirstlane_b32 s6, v119
    s_nop 0
    s_cmp_ge_u32 s6, 8
    s_cbranch_scc1 LWD_14
    s_sleep 1
    s_sub_u32 s7, s7, 1
    s_cmp_lg_u32 s7, 0
    s_cbranch_scc1 LW_13
LWD_14:
    s_sub_u32 s12, s2, 81
    s_cmp_lt_u32 s12, 64
    s_cbranch_scc1 L_klq_0
L_klo_0:
    s_mov_b32 m0, s11
    s_nop 0
    buffer_load_dwordx4 v2, s[20:23], s8 offen offset:0 nt lds
    buffer_load_dwordx4 v3, s[20:23], s8 offen offset:1024 nt lds
    buffer_load_dwordx4 v4, s[20:23], s8 offen offset:2048 nt lds
    buffer_load_dwordx4 v5, s[20:23], s8 offen offset:3072 nt lds
    s_waitcnt vmcnt(20)
    s_add_u32 s8, s8, 4096
    s_add_u32 s11, s11, 4096
    s_cmp_lt_u32 s11, 32768
    s_cbranch_scc1 L_klo_0
    s_waitcnt lgkmcnt(0)
    v_mov_b32 v118, 131100
    v_mov_b32 v119, 1
    ds_write_b32 v118, v119
L_klo_1:
    s_mov_b32 m0, s11
    s_nop 0
    buffer_load_dwordx4 v2, s[20:23], s8 offen offset:0 nt lds
    buffer_load_dwordx4 v3, s[20:23], s8 offen offset:1024 nt lds
    buffer_load_dwordx4 v4, s[20:23], s8 offen offset:2048 nt lds
    buffer_load_dwordx4 v5, s[20:23], s8 offen offset:3072 nt lds
    s_waitcnt vmcnt(20)
    s_add_u32 s8, s8, 4096
    s_add_u32 s11, s11, 4096
    s_cmp_lt_u32 s11, 131072
    s_cbranch_scc1 L_klo_1
    s_waitcnt vmcnt(16)
    s_waitcnt lgkmcnt(0)
    v_mov_b32 v118, 131200
    v_mov_b32 v119, 1
    ds_write_b32 v118, v119
    s_waitcnt vmcnt(0)
    s_waitcnt lgkmcnt(0)
    v_mov_b32 v118, 131204
    v_mov_b32 v119, 1
    ds_write_b32 v118, v119
    s_branch L_kl_done
L_klq_0:
    s_mov_b32 m0, s11
    s_nop 0
    buffer_load_dwordx4 v2, s[20:23], s8 offen offset:0 nt lds
    buffer_load_dwordx4 v3, s[20:23], s8 offen offset:1024 nt lds
    buffer_load_dwordx4 v4, s[20:23], s8 offen offset:2048 nt lds
    buffer_load_dwordx4 v5, s[20:23], s8 offen offset:3072 nt lds
    s_waitcnt vmcnt(28)
    s_add_u32 s8, s8, 4096
    s_add_u32 s11, s11, 4096
    s_cmp_lt_u32 s11, 32768
    s_cbranch_scc1 L_klq_0
    s_waitcnt lgkmcnt(0)
    v_mov_b32 v118, 131100
    v_mov_b32 v119, 1
    ds_write_b32 v118, v119
L_klq_1:
    s_mov_b32 m0, s11
    s_nop 0
    buffer_load_dwordx4 v2, s[20:23], s8 offen offset:0 nt lds
    buffer_load_dwordx4 v3, s[20:23], s8 offen offset:1024 nt lds
    buffer_load_dwordx4 v4, s[20:23], s8 offen offset:2048 nt lds
    buffer_load_dwordx4 v5, s[20:23], s8 offen offset:3072 nt lds
    s_waitcnt vmcnt(28)
    s_add_u32 s8, s8, 4096
    s_add_u32 s11, s11, 4096
    s_cmp_lt_u32 s11, 131072
    s_cbranch_scc1 L_klq_1
    s_waitcnt lgkmcnt(0)
    v_mov_b32 v118, 131200
    v_mov_b32 v119, 1
    ds_write_b32 v118, v119
    s_waitcnt vmcnt(16)
    s_waitcnt lgkmcnt(0)
    v_mov_b32 v118, 131204
    v_mov_b32 v119, 1
    ds_write_b32 v118, v119
    s_waitcnt vmcnt(0)
    s_waitcnt lgkmcnt(0)
    v_mov_b32 v118, 131208
    v_mov_b32 v119, 1
    ds_write_b32 v118, v119
L_kl_done:
    s_waitcnt vmcnt(0)
    s_waitcnt lgkmcnt(0)
    v_mov_b32 v118, 131076
    v_mov_b32 v119, 1
    ds_write_b32 v118, v119
    s_branch L_vw2
L_p1:
    s_sub_u32 s15, s2, 1
    s_cmp_ge_u32 s2, 145
    s_cbranch_scc1 L_p1_s
    s_cmp_lg_u32 s3, 0
    s_cbranch_scc1 L_qk
    s_cmp_lt_u32 s15, 80
    s_cbranch_scc1 L_p1_u
    v_mov_b32 v118, 131152
    s_mov_b32 s7, 3200000
LW_15:
    ds_read_b32 v119, v118
    s_waitcnt lgkmcnt(0)
    v_readfirstlane_b32 s6, v119
    s_nop 0
    s_cmp_ge_u32 s6, 8
    s_cbranch_scc1 LWD_16
    s_sleep 1
    s_sub_u32 s7, s7, 1
    s_cmp_lg_u32 s7, 0
    s_cbranch_scc1 LW_15
LWD_16:
    s_mov_b64 exec, 1
    v_mov_b32 v118, 131144
    v_mov_b32 v119, 8
    ds_add_u32 v118, v119
    s_mov_b64 exec, -1
    s_branch L_qk
L_p1_s:
    s_sub_u32 s13, s2, 145
    s_mul_i32 s6, s3, 111
    s_add_u32 s13, s13, s6
    s_cmp_ge_u32 s13, 160
    s_cbranch_scc1 L_qk
    s_branch L_p1_nu
L_p1_u:
    s_setprio 3
    s_mul_i32 s11, s15, 3277
    s_lshr_b32 s11, s11, 16
    s_mul_i32 s6, s11, 20
    s_sub_u32 s12, s15, s6
    s_lshl_b32 s14, s15, 8
    s_branch L_p1_go
L_p1_nu:
    s_mul_i32 s11, s13, 1639
    s_lshr_b32 s11, s11, 16
    s_mul_i32 s6, s11, 40
    s_sub_u32 s12, s13, s6
    s_lshl_b32 s14, s13, 8
    s_add_u32 s14, s14, 30720
    s_add_u32 s12, s12, 20
L_p1_go:
    s_mov_b32 s20, s52
    s_and_b32 s21, s53, 0xffff
    s_mov_b32 s22, 1280
    s_mov_b32 s23, 0x20000
    s_mov_b32 s24, s54
    s_and_b32 s25, s55, 0xffff
    s_mov_b32 s26, 4915200
    s_mov_b32 s27, 0x20000
    s_mul_i32 s6, s11, 320
    v_lshlrev_b32 v2, 1, v0
    buffer_load_ushort v4, v2, s[20:23], s6 offen offset:0
    buffer_load_ushort v5, v2, s[20:23], s6 offen offset:128
    buffer_load_ushort v6, v2, s[20:23], s6 offen offset:256
    v_lshrrev_b32 v3, 3, v0
    v_mul_u32_u24 v3, 7680, v3
    v_and_b32 v7, 7, v0
    v_lshlrev_b32 v7, 4, v7
    v_add_u32 v3, v3, v7
    s_mul_i32 s8, s11, 1228800
    s_lshl_b32 s6, s12, 7
    s_add_u32 s8, s8, s6
    buffer_load_dwordx4 v[40:43], v3, s[24:27], s8 offen nt
    s_add_u32 s8, s8, 61440
    buffer_load_dwordx4 v[44:47], v3, s[24:27], s8 offen nt
    s_add_u32 s8, s8, 61440
    buffer_load_dwordx4 v[48:51], v3, s[24:27], s8 offen nt
    s_add_u32 s8, s8, 61440
    buffer_load_dwordx4 v[52:55], v3, s[24:27], s8 offen nt
    s_add_u32 s8, s8, 61440
    buffer_load_dwordx4 v[56:59], v3, s[24:27], s8 offen nt
    s_add_u32 s8, s8, 61440
    buffer_load_dwordx4 v[60:63], v3, s[24:27], s8 offen nt
    s_add_u32 s8, s8, 61440
    buffer_load_dwordx4 v[64:67], v3, s[24:27], s8 offen nt
    s_add_u32 s8, s8, 61440
    buffer_load_dwordx4 v[68:71], v3, s[24:27], s8 offen nt
    s_add_u32 s8, s8, 61440
    buffer_load_dwordx4 v[72:75], v3, s[24:27], s8 offen nt
    s_add_u32 s8, s8, 61440
    buffer_load_dwordx4 v[76:79], v3, s[24:27], s8 offen nt
    s_add_u32 s8, s8, 61440
    buffer_load_dwordx4 v[80:83], v3, s[24:27], s8 offen nt
    s_add_u32 s8, s8, 61440
    buffer_load_dwordx4 v[84:87], v3, s[24:27], s8 offen nt
    s_add_u32 s8, s8, 61440
    buffer_load_dwordx4 v[88:91], v3, s[24:27], s8 offen nt
    s_add_u32 s8, s8, 61440
    buffer_load_dwordx4 v[92:95], v3, s[24:27], s8 offen nt
    s_add_u32 s8, s8, 61440
    buffer_load_dwordx4 v[96:99], v3, s[24:27], s8 offen nt
    s_add_u32 s8, s8, 61440
    buffer_load_dwordx4 v[100:103], v3, s[24:27], s8 offen nt
    s_add_u32 s8, s8, 61440
    buffer_load_dwordx4 v[104:107], v3, s[24:27], s8 offen nt
    s_add_u32 s8, s8, 61440
    buffer_load_dwordx4 v[108:111], v3, s[24:27], s8 offen nt
    s_add_u32 s8, s8, 61440
    buffer_load_dwordx4 v[112:115], v3, s[24:27], s8 offen nt
    s_add_u32 s8, s8, 61440
    buffer_load_dwordx4 v[116:119], v3, s[24:27], s8 offen nt
    s_cmp_lg_u32 s35, 0
    s_cbranch_scc1 BO_17
    s_barrier
    s_mov_b32 s35, 1
BO_17:
    s_cmp_lt_u32 s2, 145
    s_cbranch_scc1 L_p1_noiss
    s_mov_b64 exec, 1
    v_mov_b32 v120, 131144
    v_mov_b32 v121, 8
    ds_add_u32 v120, v121
    s_mov_b64 exec, -1
L_p1_noiss:
    s_waitcnt vmcnt(20)
    s_mov_b32 s6, 1069066811
    v_lshlrev_b32 v4, 16, v4
    v_mul_f32 v8, s6, v4
    v_exp_f32 v8, -v8
    s_nop 0
    v_add_f32 v8, 1.0, v8
    v_rcp_f32 v9, v8
    s_nop 0
    v_fma_f32 v10, -v8, v9, 1.0
    v_fma_f32 v9, v10, v9, v9
    v_mul_f32 v10, v4, v9
    v_fma_f32 v4, -v8, v10, v4
    v_fma_f32 v4, v4, v9, v10
    v_cvt_pk_bf16_f32 v4, v4, v4
    v_lshlrev_b32 v5, 16, v5
    v_mul_f32 v8, s6, v5
    v_exp_f32 v8, -v8
    s_nop 0
    v_add_f32 v8, 1.0, v8
    v_rcp_f32 v9, v8
    s_nop 0
    v_fma_f32 v10, -v8, v9, 1.0
    v_fma_f32 v9, v10, v9, v9
    v_mul_f32 v10, v5, v9
    v_fma_f32 v5, -v8, v10, v5
    v_fma_f32 v5, v5, v9, v10
    v_cvt_pk_bf16_f32 v5, v5, v5
    v_lshlrev_b32 v6, 16, v6
    v_mul_f32 v8, s6, v6
    v_exp_f32 v8, -v8
    s_nop 0
    v_add_f32 v8, 1.0, v8
    v_rcp_f32 v9, v8
    s_nop 0
    v_fma_f32 v10, -v8, v9, 1.0
    v_fma_f32 v9, v10, v9, v9
    v_mul_f32 v10, v6, v9
    v_fma_f32 v6, -v8, v10, v6
    v_fma_f32 v6, v6, v9, v10
    v_cvt_pk_bf16_f32 v6, v6, v6
    v_and_b32 v8, 7, v0
    v_mul_u32_u24 v8, 20, v8
    v_lshrrev_b32 v9, 3, v0
    v_add_u32 v8, v8, v9
    s_lshl_b32 s8, s3, 10
    s_add_u32 s8, s8, 134144
    v_lshlrev_b32 v8, 2, v8
    v_add_u32 v8, s8, v8
    ds_write_b32 v8, v4
    ds_write_b32 v8, v5 offset:32
    s_mov_b32 exec_lo, -1
    s_mov_b32 exec_hi, 0
    ds_write_b32 v8, v6 offset:64
    s_mov_b64 exec, -1
    v_lshrrev_b32 v9, 3, v0
    v_mul_u32_u24 v9, 80, v9
    v_add_u32 v9, s8, v9
    s_waitcnt lgkmcnt(0)
    ds_read_b128 v[20:23], v9 offset:0
    ds_read_b128 v[24:27], v9 offset:16
    ds_read_b128 v[28:31], v9 offset:32
    ds_read_b128 v[32:35], v9 offset:48
    ds_read_b128 v[36:39], v9 offset:64
    v_and_b32 v2, 7, v0
    v_lshlrev_b32 v2, 5, v2
    v_bfe_u32 v3, v0, 4, 1
    v_lshl_add_u32 v2, v3, 4, v2
    v_lshrrev_b32 v3, 5, v0
    v_lshl_add_u32 v2, v3, 8, v2
    v_add_u32 v2, s14, v2
    v_and_b32 v3, 7, v0
    v_and_b32 v8, 1, v3
    v_lshlrev_b32 v8, 4, v8
    v_mov_b32 v7, 0xffff
    v_lshlrev_b32 v8, v8, v7
    v_lshrrev_b32 v3, 1, v3
    v_cmp_eq_u32 vcc, 0, v3
    s_nop 1
    v_cndmask_b32 v4, 0, v8, vcc
    v_cmp_eq_u32 vcc, 1, v3
    s_nop 1
    v_cndmask_b32 v5, 0, v8, vcc
    v_cmp_eq_u32 vcc, 2, v3
    s_nop 1
    v_cndmask_b32 v6, 0, v8, vcc
    v_cmp_eq_u32 vcc, 3, v3
    s_nop 1
    v_cndmask_b32 v7, 0, v8, vcc
    s_waitcnt lgkmcnt(0)
    v_and_b32 v12, v4, v20
    v_and_b32 v13, v5, v20
    v_and_b32 v14, v6, v20
    v_and_b32 v15, v7, v20
    v_and_b32 v16, v4, v21
    v_and_b32 v17, v5, v21
    v_and_b32 v18, v6, v21
    v_and_b32 v19, v7, v21
    s_waitcnt vmcnt(19)
    v_mfma_f32_16x16x32_bf16 v[8:11], v[12:15], v[40:43], 0
    v_and_b32 v12, v4, v22
    v_and_b32 v13, v5, v22
    v_and_b32 v14, v6, v22
    v_and_b32 v15, v7, v22
    s_waitcnt vmcnt(18)
    v_mfma_f32_16x16x32_bf16 v[8:11], v[16:19], v[44:47], v[8:11]
    v_and_b32 v16, v4, v23
    v_and_b32 v17, v5, v23
    v_and_b32 v18, v6, v23
    v_and_b32 v19, v7, v23
    s_waitcnt vmcnt(17)
    v_mfma_f32_16x16x32_bf16 v[8:11], v[12:15], v[48:51], v[8:11]
    v_and_b32 v12, v4, v24
    v_and_b32 v13, v5, v24
    v_and_b32 v14, v6, v24
    v_and_b32 v15, v7, v24
    s_waitcnt vmcnt(16)
    v_mfma_f32_16x16x32_bf16 v[8:11], v[16:19], v[52:55], v[8:11]
    v_and_b32 v16, v4, v25
    v_and_b32 v17, v5, v25
    v_and_b32 v18, v6, v25
    v_and_b32 v19, v7, v25
    s_waitcnt vmcnt(15)
    v_mfma_f32_16x16x32_bf16 v[8:11], v[12:15], v[56:59], v[8:11]
    v_and_b32 v12, v4, v26
    v_and_b32 v13, v5, v26
    v_and_b32 v14, v6, v26
    v_and_b32 v15, v7, v26
    s_waitcnt vmcnt(14)
    v_mfma_f32_16x16x32_bf16 v[8:11], v[16:19], v[60:63], v[8:11]
    v_and_b32 v16, v4, v27
    v_and_b32 v17, v5, v27
    v_and_b32 v18, v6, v27
    v_and_b32 v19, v7, v27
    s_waitcnt vmcnt(13)
    v_mfma_f32_16x16x32_bf16 v[8:11], v[12:15], v[64:67], v[8:11]
    v_and_b32 v12, v4, v28
    v_and_b32 v13, v5, v28
    v_and_b32 v14, v6, v28
    v_and_b32 v15, v7, v28
    s_waitcnt vmcnt(12)
    v_mfma_f32_16x16x32_bf16 v[8:11], v[16:19], v[68:71], v[8:11]
    v_and_b32 v16, v4, v29
    v_and_b32 v17, v5, v29
    v_and_b32 v18, v6, v29
    v_and_b32 v19, v7, v29
    s_waitcnt vmcnt(11)
    v_mfma_f32_16x16x32_bf16 v[8:11], v[12:15], v[72:75], v[8:11]
    v_and_b32 v12, v4, v30
    v_and_b32 v13, v5, v30
    v_and_b32 v14, v6, v30
    v_and_b32 v15, v7, v30
    s_waitcnt vmcnt(10)
    v_mfma_f32_16x16x32_bf16 v[8:11], v[16:19], v[76:79], v[8:11]
    v_and_b32 v16, v4, v31
    v_and_b32 v17, v5, v31
    v_and_b32 v18, v6, v31
    v_and_b32 v19, v7, v31
    s_waitcnt vmcnt(9)
    v_mfma_f32_16x16x32_bf16 v[8:11], v[12:15], v[80:83], v[8:11]
    v_and_b32 v12, v4, v32
    v_and_b32 v13, v5, v32
    v_and_b32 v14, v6, v32
    v_and_b32 v15, v7, v32
    s_waitcnt vmcnt(8)
    v_mfma_f32_16x16x32_bf16 v[8:11], v[16:19], v[84:87], v[8:11]
    v_and_b32 v16, v4, v33
    v_and_b32 v17, v5, v33
    v_and_b32 v18, v6, v33
    v_and_b32 v19, v7, v33
    s_waitcnt vmcnt(7)
    v_mfma_f32_16x16x32_bf16 v[8:11], v[12:15], v[88:91], v[8:11]
    v_and_b32 v12, v4, v34
    v_and_b32 v13, v5, v34
    v_and_b32 v14, v6, v34
    v_and_b32 v15, v7, v34
    s_waitcnt vmcnt(6)
    v_mfma_f32_16x16x32_bf16 v[8:11], v[16:19], v[92:95], v[8:11]
    v_and_b32 v16, v4, v35
    v_and_b32 v17, v5, v35
    v_and_b32 v18, v6, v35
    v_and_b32 v19, v7, v35
    s_waitcnt vmcnt(5)
    v_mfma_f32_16x16x32_bf16 v[8:11], v[12:15], v[96:99], v[8:11]
    v_and_b32 v12, v4, v36
    v_and_b32 v13, v5, v36
    v_and_b32 v14, v6, v36
    v_and_b32 v15, v7, v36
    s_waitcnt vmcnt(4)
    v_mfma_f32_16x16x32_bf16 v[8:11], v[16:19], v[100:103], v[8:11]
    v_and_b32 v16, v4, v37
    v_and_b32 v17, v5, v37
    v_and_b32 v18, v6, v37
    v_and_b32 v19, v7, v37
    s_waitcnt vmcnt(3)
    v_mfma_f32_16x16x32_bf16 v[8:11], v[12:15], v[104:107], v[8:11]
    v_and_b32 v12, v4, v38
    v_and_b32 v13, v5, v38
    v_and_b32 v14, v6, v38
    v_and_b32 v15, v7, v38
    s_waitcnt vmcnt(2)
    v_mfma_f32_16x16x32_bf16 v[8:11], v[16:19], v[108:111], v[8:11]
    v_and_b32 v16, v4, v39
    v_and_b32 v17, v5, v39
    v_and_b32 v18, v6, v39
    v_and_b32 v19, v7, v39
    s_waitcnt vmcnt(1)
    v_mfma_f32_16x16x32_bf16 v[8:11], v[12:15], v[112:115], v[8:11]
    s_nop 1
    s_waitcnt vmcnt(0)
    v_mfma_f32_16x16x32_bf16 v[8:11], v[16:19], v[116:119], v[8:11]
    s_nop 7
    v_mov_b32 v12, v8
    v_mov_b32 v13, v9
    v_mov_b32 v14, v10
    v_mov_b32 v15, v11
    s_nop 1
    v_permlane32_swap_b32 v8, v12
    v_permlane32_swap_b32 v9, v13
    v_permlane32_swap_b32 v10, v14
    v_permlane32_swap_b32 v11, v15
    s_nop 1
    v_add_f32_dpp v8, v12, v8 row_ror:8 row_mask:0xf bank_mask:0xf
    v_add_f32_dpp v9, v13, v9 row_ror:8 row_mask:0xf bank_mask:0xf
    v_add_f32_dpp v10, v14, v10 row_ror:8 row_mask:0xf bank_mask:0xf
    v_add_f32_dpp v11, v15, v11 row_ror:8 row_mask:0xf bank_mask:0xf
    s_cmp_ge_u32 s15, 80
    s_cbranch_scc1 L_p1_late
    v_mov_b32 v118, 131148
    s_mov_b32 s7, 3200000
LW_18:
    ds_read_b32 v119, v118
    s_waitcnt lgkmcnt(0)
    v_readfirstlane_b32 s6, v119
    s_nop 0
    s_cmp_ge_u32 s6, 1
    s_cbranch_scc1 LWD_19
    s_sleep 1
    s_sub_u32 s7, s7, 1
    s_cmp_lg_u32 s7, 0
    s_cbranch_scc1 LW_18
LWD_19:
    s_branch L_p1_pub
L_p1_late:
    v_mov_b32 v118, 131096
    s_mov_b32 s7, 3200000
LW_20:
    ds_read_b32 v119, v118
    s_waitcnt lgkmcnt(0)
    v_readfirstlane_b32 s6, v119
    s_nop 0
    s_cmp_ge_u32 s6, 1
    s_cbranch_scc1 LWD_21
    s_sleep 4
    s_sub_u32 s7, s7, 1
    s_cmp_lg_u32 s7, 0
    s_cbranch_scc1 LW_20
LWD_21:
L_p1_pub:
    s_mov_b32 exec_lo, 0x00ff00ff
    s_mov_b32 exec_hi, 0
    global_store_dwordx4 v2, v[8:11], s[16:17] sc1
    s_mov_b64 exec, -1
    s_mov_b64 exec, 1
    v_mov_b32 v118, 131144
    v_mov_b32 v119, 8
    ds_add_u32 v118, v119
    s_mov_b64 exec, -1
    s_setprio 0
    s_branch L_qk
L_p2:
    s_setprio 3
    s_mov_b32 s20, s36
    s_and_b32 s21, s37, 0xffff
    s_mov_b32 s22, 1280
    s_mov_b32 s23, 0x20000
    s_mov_b32 s24, s42
    s_and_b32 s25, s43, 0xffff
    s_mov_b32 s26, 5242880
    s_mov_b32 s27, 0x20000
    s_mov_b32 s13, s3
    s_and_b32 s6, s11, 7
    s_lshl_b32 s6, s6, 3
    s_lshr_b32 s11, s11, 3
    s_add_u32 s11, s11, s6
    v_mul_u32_u24 v2, 20, v0
    buffer_load_dwordx4 v[4:7], v2, s[20:23], 0 offen
    buffer_load_dword v8, v2, s[20:23], 0 offen offset:16
    s_mul_i32 s6, s13, 160
    v_lshlrev_b32 v3, 2, v0
    buffer_load_dword v10, v3, s[20:23], s6 offen
    v_lshrrev_b32 v3, 3, v0
    v_lshlrev_b32 v3, 13, v3
    v_and_b32 v9, 7, v0
    v_lshlrev_b32 v9, 4, v9
    v_add_u32 v3, v3, v9
    s_mul_i32 s8, s13, 655360
    s_lshl_b32 s6, s11, 7
    s_add_u32 s8, s8, s6
    buffer_load_dwordx4 v[76:79], v3, s[24:27], s8 offen nt
    s_add_u32 s8, s8, 65536
    buffer_load_dwordx4 v[80:83], v3, s[24:27], s8 offen nt
    s_add_u32 s8, s8, 65536
    buffer_load_dwordx4 v[84:87], v3, s[24:27], s8 offen nt
    s_add_u32 s8, s8, 65536
    buffer_load_dwordx4 v[88:91], v3, s[24:27], s8 offen nt
    s_add_u32 s8, s8, 65536
    buffer_load_dwordx4 v[92:95], v3, s[24:27], s8 offen nt
    s_add_u32 s8, s8, 65536
    buffer_load_dwordx4 v[96:99], v3, s[24:27], s8 offen nt
    s_add_u32 s8, s8, 65536
    buffer_load_dwordx4 v[100:103], v3, s[24:27], s8 offen nt
    s_add_u32 s8, s8, 65536
    buffer_load_dwordx4 v[104:107], v3, s[24:27], s8 offen nt
    s_add_u32 s8, s8, 65536
    buffer_load_dwordx4 v[108:111], v3, s[24:27], s8 offen nt
    s_add_u32 s8, s8, 65536
    buffer_load_dwordx4 v[112:115], v3, s[24:27], s8 offen nt
    s_cmp_lg_u32 s35, 0
    s_cbranch_scc1 BO_22
    s_barrier
    s_mov_b32 s35, 1
BO_22:
    s_waitcnt vmcnt(10)
    v_lshlrev_b32 v12, 16, v4
    v_and_b32 v13, 0xffff0000, v4
    v_lshlrev_b32 v14, 16, v5
    v_and_b32 v15, 0xffff0000, v5
    v_lshlrev_b32 v16, 16, v6
    v_and_b32 v17, 0xffff0000, v6
    v_lshlrev_b32 v18, 16, v7
    v_and_b32 v19, 0xffff0000, v7
    v_lshlrev_b32 v20, 16, v8
    v_and_b32 v21, 0xffff0000, v8
    v_add_f32 v22, v12, v13
    v_add_f32 v22, v22, v14
    v_add_f32 v22, v22, v15
    v_add_f32 v22, v22, v16
    v_add_f32 v22, v22, v17
    v_add_f32 v22, v22, v18
    v_add_f32 v22, v22, v19
    v_add_f32 v22, v22, v20
    v_add_f32 v22, v22, v21
    s_nop 1
    v_add_f32_dpp v22, v22, v22 row_ror:8 row_mask:0xf bank_mask:0xf
    s_nop 1
    v_add_f32_dpp v22, v22, v22 row_ror:4 row_mask:0xf bank_mask:0xf
    s_nop 1
    v_add_f32_dpp v22, v22, v22 row_ror:2 row_mask:0xf bank_mask:0xf
    s_nop 1
    v_add_f32_dpp v22, v22, v22 row_ror:1 row_mask:0xf bank_mask:0xf
    v_mov_b32 v24, v22
    s_nop 1
    v_permlane16_swap_b32 v22, v24
    v_add_f32 v22, v22, v24
    v_mov_b32 v24, v22
    s_nop 1
    v_permlane32_swap_b32 v22, v24
    v_add_f32 v22, v22, v24
    v_mul_f32 v22, 0x3acccccd, v22
    v_sub_f32 v24, v12, v22
    v_mul_f32 v23, v24, v24
    v_sub_f32 v24, v13, v22
    v_fmac_f32 v23, v24, v24
    v_sub_f32 v24, v14, v22
    v_fmac_f32 v23, v24, v24
    v_sub_f32 v24, v15, v22
    v_fmac_f32 v23, v24, v24
    v_sub_f32 v24, v16, v22
    v_fmac_f32 v23, v24, v24
    v_sub_f32 v24, v17, v22
    v_fmac_f32 v23, v24, v24
    v_sub_f32 v24, v18, v22
    v_fmac_f32 v23, v24, v24
    v_sub_f32 v24, v19, v22
    v_fmac_f32 v23, v24, v24
    v_sub_f32 v24, v20, v22
    v_fmac_f32 v23, v24, v24
    v_sub_f32 v24, v21, v22
    v_fmac_f32 v23, v24, v24
    s_nop 1
    v_add_f32_dpp v23, v23, v23 row_ror:8 row_mask:0xf bank_mask:0xf
    s_nop 1
    v_add_f32_dpp v23, v23, v23 row_ror:4 row_mask:0xf bank_mask:0xf
    s_nop 1
    v_add_f32_dpp v23, v23, v23 row_ror:2 row_mask:0xf bank_mask:0xf
    s_nop 1
    v_add_f32_dpp v23, v23, v23 row_ror:1 row_mask:0xf bank_mask:0xf
    v_mov_b32 v24, v23
    s_nop 1
    v_permlane16_swap_b32 v23, v24
    v_add_f32 v23, v23, v24
    v_mov_b32 v24, v23
    s_nop 1
    v_permlane32_swap_b32 v23, v24
    v_add_f32 v23, v23, v24
    v_mul_f32 v23, 0x3acccccd, v23
    v_cvt_pk_bf16_f32 v23, v23, v23
    v_and_b32 v23, 0xffff0000, v23
    v_cvt_pk_bf16_f32 v22, v22, v22
    v_and_b32 v22, 0xffff0000, v22
    v_add_f32 v23, 0x3727c5ac, v23
    v_cvt_pk_bf16_f32 v23, v23, v23
    v_and_b32 v23, 0xffff0000, v23
    v_sqrt_f32 v24, v23
    s_nop 0
    v_rcp_f32 v25, v24
    v_fma_f32 v23, -v24, v24, v23
    v_mul_f32 v25, 0.5, v25
    v_fma_f32 v23, v23, v25, v24
    v_cvt_pk_bf16_f32 v23, v23, v23
    v_and_b32 v23, 0xffff0000, v23
    v_lshlrev_b32 v4, 16, v10
    v_and_b32 v5, 0xffff0000, v10
    v_sub_f32 v4, v4, v22
    v_cvt_pk_bf16_f32 v4, v4, v4
    v_and_b32 v4, 0xffff0000, v4
    v_rcp_f32 v24, v23
    s_nop 0
    v_fma_f32 v25, -v23, v24, 1.0
    v_fma_f32 v24, v25, v24, v24
    v_mul_f32 v25, v4, v24
    v_fma_f32 v4, -v23, v25, v4
    v_fma_f32 v4, v4, v24, v25
    v_cvt_pk_bf16_f32 v4, v4, v4
    v_and_b32 v4, 0xffff0000, v4
    v_sub_f32 v5, v5, v22
    v_cvt_pk_bf16_f32 v5, v5, v5
    v_and_b32 v5, 0xffff0000, v5
    v_rcp_f32 v24, v23
    s_nop 0
    v_fma_f32 v25, -v23, v24, 1.0
    v_fma_f32 v24, v25, v24, v24
    v_mul_f32 v25, v5, v24
    v_fma_f32 v5, -v23, v25, v5
    v_fma_f32 v5, v5, v24, v25
    v_cvt_pk_bf16_f32 v5, v5, v5
    v_and_b32 v5, 0xffff0000, v5
    s_mul_i32 s6, s13, 320
    v_lshlrev_b32 v2, 3, v0
    v_add_u32 v2, s6, v2
    v_add_u32 v32, 5120, v2
    v_add_u32 v33, 10240, v2
    v_add_u32 v34, 15360, v2
    s_mov_b32 s14, s3
    s_lshl_b32 s6, s14, 9
    s_add_u32 s6, s6, 136192
    v_and_b32 v116, 3, v0
    v_mul_u32_u24 v116, 96, v116
    v_lshrrev_b32 v117, 2, v0
    v_lshl_add_u32 v116, v117, 2, v116
    v_add_u32 v116, s6, v116
    v_lshrrev_b32 v117, 3, v0
    v_mul_u32_u24 v117, 48, v117
    v_add_u32 v117, s6, v117
    v_and_b32 v3, 7, v0
    v_lshlrev_b32 v3, 5, v3
    v_bfe_u32 v120, v0, 4, 1
    v_lshl_add_u32 v3, v120, 4, v3
    v_lshrrev_b32 v120, 5, v0
    v_lshl_add_u32 v3, v120, 8, v3
    s_lshl_b32 s6, s14, 9
    s_add_u32 s6, s6, 144384
    v_add_u32 v3, s6, v3
    v_and_b32 v120, 7, v0
    v_and_b32 v121, 1, v120
    v_lshlrev_b32 v121, 4, v121
    v_mov_b32 v75, 0xffff
    v_lshlrev_b32 v121, v121, v75
    v_lshrrev_b32 v120, 1, v120
    v_cmp_eq_u32 vcc, 0, v120
    s_nop 1
    v_cndmask_b32 v72, 0, v121, vcc
    v_cmp_eq_u32 vcc, 1, v120
    s_nop 1
    v_cndmask_b32 v73, 0, v121, vcc
    v_cmp_eq_u32 vcc, 2, v120
    s_nop 1
    v_cndmask_b32 v74, 0, v121, vcc
    v_cmp_eq_u32 vcc, 3, v120
    s_nop 1
    v_cndmask_b32 v75, 0, v121, vcc
    s_waitcnt vmcnt(0)
    s_mov_b64 exec, 1
    v_mov_b32 v118, 131144
    v_mov_b32 v119, 1
    ds_add_u32 v118, v119
    s_mov_b64 exec, -1
    v_mov_b32 v118, 131148
    s_mov_b32 s7, 3200000
LW_23:
    ds_read_b32 v119, v118
    s_waitcnt lgkmcnt(0)
    v_readfirstlane_b32 s6, v119
    s_nop 0
    s_cmp_ge_u32 s6, 1
    s_cbranch_scc1 LWD_24
    s_sleep 2
    s_sub_u32 s7, s7, 1
    s_cmp_lg_u32 s7, 0
    s_cbranch_scc1 LW_23
LWD_24:
    s_waitcnt vmcnt(0)
    s_mov_b32 exec_lo, -1
    s_mov_b32 exec_hi, 0xff
    s_mov_b32 s7, 400000
GP_25:
    global_load_dwordx2 v[40:41], v2, s[16:17] sc1
    global_load_dwordx2 v[48:49], v2, s[16:17] offset:2560 sc1
    global_load_dwordx2 v[42:43], v32, s[16:17] sc1
    global_load_dwordx2 v[50:51], v32, s[16:17] offset:2560 sc1
    global_load_dwordx2 v[44:45], v33, s[16:17] sc1
    global_load_dwordx2 v[52:53], v33, s[16:17] offset:2560 sc1
    global_load_dwordx2 v[46:47], v34, s[16:17] sc1
    global_load_dwordx2 v[54:55], v34, s[16:17] offset:2560 sc1
    s_waitcnt vmcnt(0)
    v_max_u32 v121, v40, v41
    v_max3_u32 v121, v121, v42, v43
    v_max3_u32 v121, v121, v44, v45
    v_max3_u32 v121, v121, v46, v47
    v_max3_u32 v121, v121, v48, v49
    v_max3_u32 v121, v121, v50, v51
    v_max3_u32 v121, v121, v52, v53
    v_max3_u32 v121, v121, v54, v55
    v_cmp_eq_u32 vcc, -1, v121
    s_nop 0
    s_cbranch_vccz GPD_26
    s_sub_u32 s7, s7, 1
    s_cmp_lg_u32 s7, 0
    s_cbranch_scc1 GP_25
GPD_26:
    v_add_f32 v6, v40, v42
    v_add_f32 v6, v6, v44
    v_add_f32 v6, v6, v46
    v_add_f32 v36, v48, v50
    v_add_f32 v36, v36, v52
    v_add_f32 v36, v36, v54
    v_add_f32 v7, v41, v43
    v_add_f32 v7, v7, v45
    v_add_f32 v7, v7, v47
    v_add_f32 v37, v49, v51
    v_add_f32 v37, v37, v53
    v_add_f32 v37, v37, v55
    v_cvt_pk_bf16_f32 v6, v6, v6
    v_and_b32 v6, 0xffff0000, v6
    v_cvt_pk_bf16_f32 v36, v36, v36
    v_and_b32 v36, 0xffff0000, v36
    v_cvt_pk_bf16_f32 v7, v7, v7
    v_and_b32 v7, 0xffff0000, v7
    v_cvt_pk_bf16_f32 v37, v37, v37
    v_and_b32 v37, 0xffff0000, v37
    v_add_f32 v36, 1.0, v36
    v_add_f32 v37, 1.0, v37
    v_cvt_pk_bf16_f32 v36, v36, v36
    v_and_b32 v36, 0xffff0000, v36
    v_cvt_pk_bf16_f32 v37, v37, v37
    v_and_b32 v37, 0xffff0000, v37
    v_mul_f32 v4, v4, v36
    v_mul_f32 v5, v5, v37
    v_cvt_pk_bf16_f32 v4, v4, v4
    v_and_b32 v4, 0xffff0000, v4
    v_cvt_pk_bf16_f32 v5, v5, v5
    v_and_b32 v5, 0xffff0000, v5
    v_add_f32 v4, v4, v6
    v_add_f32 v5, v5, v7
    v_cvt_pk_bf16_f32 v4, v4, v4
    v_cvt_pk_bf16_f32 v5, v5, v5
    ds_write_b32 v116, v4 offset:0
    ds_write_b32 v116, v5 offset:48
    s_mov_b64 exec, -1
    s_waitcnt lgkmcnt(0)
    ds_read_b128 v[20:23], v117
    ds_read_b128 v[24:27], v117 offset:16
    ds_read_b64 v[28:29], v117 offset:32
    s_waitcnt lgkmcnt(0)
    v_and_b32 v12, v72, v20
    v_and_b32 v13, v73, v20
    v_and_b32 v14, v74, v20
    v_and_b32 v15, v75, v20
    v_and_b32 v16, v72, v21
    v_and_b32 v17, v73, v21
    v_and_b32 v18, v74, v21
    v_and_b32 v19, v75, v21
    v_mfma_f32_16x16x32_bf16 v[8:11], v[12:15], v[76:79], 0
    v_and_b32 v12, v72, v22
    v_and_b32 v13, v73, v22
    v_and_b32 v14, v74, v22
    v_and_b32 v15, v75, v22
    v_mfma_f32_16x16x32_bf16 v[8:11], v[16:19], v[80:83], v[8:11]
    v_and_b32 v16, v72, v23
    v_and_b32 v17, v73, v23
    v_and_b32 v18, v74, v23
    v_and_b32 v19, v75, v23
    v_mfma_f32_16x16x32_bf16 v[8:11], v[12:15], v[84:87], v[8:11]
    v_and_b32 v12, v72, v24
    v_and_b32 v13, v73, v24
    v_and_b32 v14, v74, v24
    v_and_b32 v15, v75, v24
    v_mfma_f32_16x16x32_bf16 v[8:11], v[16:19], v[88:91], v[8:11]
    v_and_b32 v16, v72, v25
    v_and_b32 v17, v73, v25
    v_and_b32 v18, v74, v25
    v_and_b32 v19, v75, v25
    v_mfma_f32_16x16x32_bf16 v[8:11], v[12:15], v[92:95], v[8:11]
    v_and_b32 v12, v72, v26
    v_and_b32 v13, v73, v26
    v_and_b32 v14, v74, v26
    v_and_b32 v15, v75, v26
    v_mfma_f32_16x16x32_bf16 v[8:11], v[16:19], v[96:99], v[8:11]
    v_and_b32 v16, v72, v27
    v_and_b32 v17, v73, v27
    v_and_b32 v18, v74, v27
    v_and_b32 v19, v75, v27
    v_mfma_f32_16x16x32_bf16 v[8:11], v[12:15], v[100:103], v[8:11]
    v_and_b32 v12, v72, v28
    v_and_b32 v13, v73, v28
    v_and_b32 v14, v74, v28
    v_and_b32 v15, v75, v28
    v_mfma_f32_16x16x32_bf16 v[8:11], v[16:19], v[104:107], v[8:11]
    v_and_b32 v16, v72, v29
    v_and_b32 v17, v73, v29
    v_and_b32 v18, v74, v29
    v_and_b32 v19, v75, v29
    v_mfma_f32_16x16x32_bf16 v[8:11], v[12:15], v[108:111], v[8:11]
    s_nop 1
    v_mfma_f32_16x16x32_bf16 v[8:11], v[16:19], v[112:115], v[8:11]
    s_nop 7
    s_mov_b32 exec_lo, 0x00ff00ff
    s_mov_b32 exec_hi, 0xff00ff00
    ds_write_b128 v3, v[8:11]
    s_mov_b64 exec, -1
    s_mov_b64 exec, 1
    s_waitcnt lgkmcnt(0)
    v_mov_b32 v118, 131092
    v_mov_b32 v119, 1
    ds_add_rtn_u32 v119, v118, v119
    s_waitcnt lgkmcnt(0)
    v_readfirstlane_b32 s6, v119
    s_mov_b64 exec, -1
    s_cmp_lg_u32 s6, 7
    s_cbranch_scc1 L_p2_done
    s_mov_b32 exec_lo, -1
    s_mov_b32 exec_hi, 0
    v_lshlrev_b32 v2, 3, v0
    v_add_u32 v3, 144384, v2
    ds_read_b64 v[20:21], v3 offset:0
    ds_read_b64 v[22:23], v3 offset:256
    ds_read_b64 v[24:25], v3 offset:512
    ds_read_b64 v[26:27], v3 offset:768
    ds_read_b64 v[28:29], v3 offset:1024
    ds_read_b64 v[30:31], v3 offset:1280
    ds_read_b64 v[32:33], v3 offset:1536
    ds_read_b64 v[34:35], v3 offset:1792
    ds_read_b64 v[36:37], v3 offset:2048
    ds_read_b64 v[38:39], v3 offset:2304
    ds_read_b64 v[40:41], v3 offset:2560
    ds_read_b64 v[42:43], v3 offset:2816
    ds_read_b64 v[44:45], v3 offset:3072
    ds_read_b64 v[46:47], v3 offset:3328
    ds_read_b64 v[48:49], v3 offset:3584
    ds_read_b64 v[50:51], v3 offset:3840
    s_lshl_b32 s8, s11, 7
    s_add_u32 s8, s8, 20480
    v_lshlrev_b32 v2, 2, v0
    v_add_u32 v2, s8, v2
    s_waitcnt lgkmcnt(0)
    v_add_f32 v20, v20, v22
    v_add_f32 v21, v21, v23
    v_add_f32 v24, v24, v26
    v_add_f32 v25, v25, v27
    v_add_f32 v28, v28, v30
    v_add_f32 v29, v29, v31
    v_add_f32 v32, v32, v34
    v_add_f32 v33, v33, v35
    v_add_f32 v36, v36, v38
    v_add_f32 v37, v37, v39
    v_add_f32 v40, v40, v42
    v_add_f32 v41, v41, v43
    v_add_f32 v44, v44, v46
    v_add_f32 v45, v45, v47
    v_add_f32 v48, v48, v50
    v_add_f32 v49, v49, v51
    v_add_f32 v20, v20, v24
    v_add_f32 v21, v21, v25
    v_add_f32 v28, v28, v32
    v_add_f32 v29, v29, v33
    v_add_f32 v36, v36, v40
    v_add_f32 v37, v37, v41
    v_add_f32 v44, v44, v48
    v_add_f32 v45, v45, v49
    v_add_f32 v20, v20, v28
    v_add_f32 v21, v21, v29
    v_add_f32 v36, v36, v44
    v_add_f32 v37, v37, v45
    v_add_f32 v20, v20, v36
    v_add_f32 v21, v21, v37
    v_cvt_pk_bf16_f32 v20, v20, v21
    global_store_dword v2, v20, s[16:17] sc1
    s_mov_b64 exec, -1
    s_mov_b64 exec, 1
    v_mov_b32 v118, 131144
    v_mov_b32 v119, 8
    ds_add_u32 v118, v119
    s_mov_b64 exec, -1
L_p2_done:
    s_setprio 0
    s_branch L_roles2
L_qget:
    s_cmp_lg_u32 s35, 0
    s_cbranch_scc1 BO_27
    s_barrier
    s_mov_b32 s35, 1
BO_27:
    v_mov_b32 v118, 131148
    s_mov_b32 s7, 3200000
LW_28:
    ds_read_b32 v119, v118
    s_waitcnt lgkmcnt(0)
    v_readfirstlane_b32 s6, v119
    s_nop 0
    s_cmp_ge_u32 s6, 1
    s_cbranch_scc1 LWD_29
    s_sleep 4
    s_sub_u32 s7, s7, 1
    s_cmp_lg_u32 s7, 0
    s_cbranch_scc1 LW_28
LWD_29:
    s_lshl_b32 s6, s4, 8
    s_add_u32 s6, s6, 20480
    v_lshlrev_b32 v2, 2, v0
    v_add_u32 v3, s6, v2
    s_mov_b32 s7, 400000
GP_30:
    global_load_dword v4, v3, s[16:17] sc1
    s_waitcnt vmcnt(0)
    v_cmp_eq_u32 vcc, -1, v4
    s_nop 0
    s_cbranch_vccz GPD_31
    s_sleep 16
    s_sub_u32 s7, s7, 1
    s_cmp_lg_u32 s7, 0
    s_cbranch_scc1 GP_30
GPD_31:
    v_add_u32 v2, 131328, v2
    ds_write_b32 v2, v4
    s_waitcnt lgkmcnt(0)
    v_mov_b32 v118, 131072
    v_mov_b32 v119, 1
    ds_write_b32 v118, v119
L_qk:
    s_cmp_lg_u32 s35, 0
    s_cbranch_scc1 BO_32
    s_barrier
    s_mov_b32 s35, 1
BO_32:
    s_setprio 2
    v_and_b32 v6, 15, v0
    v_lshrrev_b32 v7, 4, v0
    s_lshl_b32 s8, s3, 14
    v_add_u32 v8, 0, v7
    v_xor_b32 v8, v8, v6
    v_lshlrev_b32 v8, 4, v8
    v_lshl_add_u32 v2, v6, 8, v8
    v_add_u32 v2, s8, v2
    v_add_u32 v8, 4, v7
    v_xor_b32 v8, v8, v6
    v_lshlrev_b32 v8, 4, v8
    v_lshl_add_u32 v3, v6, 8, v8
    v_add_u32 v3, s8, v3
    v_add_u32 v8, 8, v7
    v_xor_b32 v8, v8, v6
    v_lshlrev_b32 v8, 4, v8
    v_lshl_add_u32 v4, v6, 8, v8
    v_add_u32 v4, s8, v4
    v_add_u32 v8, 12, v7
    v_xor_b32 v8, v8, v6
    v_lshlrev_b32 v8, 4, v8
    v_lshl_add_u32 v5, v6, 8, v8
    v_add_u32 v5, s8, v5
    v_lshlrev_b32 v7, 4, v7
    v_add_u32 v7, 131328, v7
    v_and_b32 v112, 3, v0
    v_lshlrev_b32 v112, 4, v112
    v_and_b32 v8, 12, v0
    v_add_u32 v112, v112, v8
    v_lshrrev_b32 v8, 4, v0
    v_add_u32 v112, v112, v8
    v_lshlrev_b32 v112, 2, v112
    s_lshl_b32 s8, s3, 8
    s_add_u32 s8, s8, 132096
    v_add_u32 v112, s8, v112
    v_mov_b32 v118, 131076
    s_mov_b32 s7, 3200000
LW_33:
    ds_read_b32 v119, v118
    s_waitcnt lgkmcnt(0)
    v_readfirstlane_b32 s6, v119
    s_nop 0
    s_cmp_ge_u32 s6, 1
    s_cbranch_scc1 LWD_34
    s_sleep 4
    s_sub_u32 s7, s7, 1
    s_cmp_lg_u32 s7, 0
    s_cbranch_scc1 LW_33
LWD_34:
    ds_read_b128 v[32:35], v2 offset:0
    ds_read_b128 v[36:39], v3 offset:0
    ds_read_b128 v[40:43], v4 offset:0
    ds_read_b128 v[44:47], v5 offset:0
    ds_read_b128 v[48:51], v2 offset:4096
    ds_read_b128 v[52:55], v3 offset:4096
    ds_read_b128 v[56:59], v4 offset:4096
    ds_read_b128 v[60:63], v5 offset:4096
    ds_read_b128 v[64:67], v2 offset:8192
    ds_read_b128 v[68:71], v3 offset:8192
    ds_read_b128 v[72:75], v4 offset:8192
    ds_read_b128 v[76:79], v5 offset:8192
    ds_read_b128 v[80:83], v2 offset:12288
    ds_read_b128 v[84:87], v3 offset:12288
    ds_read_b128 v[88:91], v4 offset:12288
    ds_read_b128 v[92:95], v5 offset:12288
    v_mov_b32 v118, 131072
    s_mov_b32 s7, 3200000
LW_35:
    ds_read_b32 v119, v118
    s_waitcnt lgkmcnt(0)
    v_readfirstlane_b32 s6, v119
    s_nop 0
    s_cmp_ge_u32 s6, 1
    s_cbranch_scc1 LWD_36
    s_sleep 1
    s_sub_u32 s7, s7, 1
    s_cmp_lg_u32 s7, 0
    s_cbranch_scc1 LW_35
LWD_36:
    ds_read_b128 v[96:99], v7 offset:0
    ds_read_b128 v[100:103], v7 offset:64
    ds_read_b128 v[104:107], v7 offset:128
    ds_read_b128 v[108:111], v7 offset:192
    s_mov_b32 s12, 0xff00ff00
    s_mov_b32 s13, 0xff00ff00
    s_mov_b32 s14, 0xf0f0f0f0
    s_mov_b32 s15, 0xf0f0f0f0
    s_mov_b32 s28, 0xcccccccc
    s_mov_b32 s29, 0xcccccccc
    s_mov_b32 s30, 0xaaaaaaaa
    s_mov_b32 s31, 0xaaaaaaaa
    s_waitcnt lgkmcnt(0)
    v_mfma_f32_16x16x32_bf16 v[12:15], v[32:35], v[96:99], 0
    v_mfma_f32_16x16x32_bf16 v[16:19], v[48:51], v[96:99], 0
    v_mfma_f32_16x16x32_bf16 v[20:23], v[64:67], v[96:99], 0
    v_mfma_f32_16x16x32_bf16 v[24:27], v[80:83], v[96:99], 0
    v_mfma_f32_16x16x32_bf16 v[12:15], v[36:39], v[100:103], v[12:15]
    v_mfma_f32_16x16x32_bf16 v[16:19], v[52:55], v[100:103], v[16:19]
    v_mfma_f32_16x16x32_bf16 v[20:23], v[68:71], v[100:103], v[20:23]
    v_mfma_f32_16x16x32_bf16 v[24:27], v[84:87], v[100:103], v[24:27]
    v_mfma_f32_16x16x32_bf16 v[12:15], v[40:43], v[104:107], v[12:15]
    v_mfma_f32_16x16x32_bf16 v[16:19], v[56:59], v[104:107], v[16:19]
    v_mfma_f32_16x16x32_bf16 v[20:23], v[72:75], v[104:107], v[20:23]
    v_mfma_f32_16x16x32_bf16 v[24:27], v[88:91], v[104:107], v[24:27]
    v_mfma_f32_16x16x32_bf16 v[12:15], v[44:47], v[108:111], v[12:15]
    v_mfma_f32_16x16x32_bf16 v[16:19], v[60:63], v[108:111], v[16:19]
    v_mfma_f32_16x16x32_bf16 v[20:23], v[76:79], v[108:111], v[20:23]
    v_mfma_f32_16x16x32_bf16 v[24:27], v[92:95], v[108:111], v[24:27]
    s_nop 7
    v_cndmask_b32 v12, v12, v16, s[14:15]
    v_cndmask_b32 v20, v20, v24, s[14:15]
    v_cndmask_b32 v13, v13, v17, s[14:15]
    v_cndmask_b32 v21, v21, v25, s[14:15]
    v_cndmask_b32 v14, v14, v18, s[14:15]
    v_cndmask_b32 v22, v22, v26, s[14:15]
    v_cndmask_b32 v15, v15, v19, s[14:15]
    v_cndmask_b32 v23, v23, v27, s[14:15]
    v_cndmask_b32 v12, v12, v20, s[12:13]
    v_cndmask_b32 v13, v13, v21, s[12:13]
    v_cndmask_b32 v14, v14, v22, s[12:13]
    v_cndmask_b32 v15, v15, v23, s[12:13]
    v_cndmask_b32 v12, v12, v13, s[30:31]
    v_cndmask_b32 v14, v14, v15, s[30:31]
    v_cndmask_b32 v8, v12, v14, s[28:29]
    v_cvt_pk_bf16_f32 v8, v8, v8
    v_and_b32 v8, 0xffff0000, v8
    v_mul_f32 v8, 0x3db504f3, v8
    v_cvt_pk_bf16_f32 v8, v8, v8
    v_and_b32 v8, 0xffff0000, v8
    ds_write_b32 v112, v8
    v_mov_b32 v9, v8
    s_nop 1
    v_max_f32_dpp v9, v9, v9 row_ror:8 row_mask:0xf bank_mask:0xf
    s_nop 1
    v_max_f32_dpp v9, v9, v9 row_ror:4 row_mask:0xf bank_mask:0xf
    s_nop 1
    v_max_f32_dpp v9, v9, v9 row_ror:2 row_mask:0xf bank_mask:0xf
    s_nop 1
    v_max_f32_dpp v9, v9, v9 row_ror:1 row_mask:0xf bank_mask:0xf
    v_mov_b32 v10, v9
    s_nop 1
    v_permlane16_swap_b32 v9, v10
    v_max_f32 v9, v9, v10
    v_mov_b32 v10, v9
    s_nop 1
    v_permlane32_swap_b32 v9, v10
    v_max_f32 v9, v9, v10
    s_mov_b32 s6, 1069066811
    v_sub_f32 v10, v8, v9
    v_mul_f32 v10, s6, v10
    v_exp_f32 v10, v10
    s_nop 0
    s_nop 1
    v_add_f32_dpp v10, v10, v10 row_ror:8 row_mask:0xf bank_mask:0xf
    s_nop 1
    v_add_f32_dpp v10, v10, v10 row_ror:4 row_mask:0xf bank_mask:0xf
    s_nop 1
    v_add_f32_dpp v10, v10, v10 row_ror:2 row_mask:0xf bank_mask:0xf
    s_nop 1
    v_add_f32_dpp v10, v10, v10 row_ror:1 row_mask:0xf bank_mask:0xf
    v_mov_b32 v11, v10
    s_nop 1
    v_permlane16_swap_b32 v10, v11
    v_add_f32 v10, v10, v11
    v_mov_b32 v11, v10
    s_nop 1
    v_permlane32_swap_b32 v10, v11
    v_add_f32 v10, v10, v11
    s_lshl_b32 s6, s3, 3
    s_add_u32 s6, s6, 131584
    v_mov_b32 v2, s6
    v_mov_b32 v11, v10
    v_mov_b32 v10, v9
    s_mov_b64 exec, 1
    ds_write_b64 v2, v[10:11]
    s_mov_b64 exec, -1
    s_mov_b64 exec, 1
    s_waitcnt lgkmcnt(0)
    v_mov_b32 v118, 131080
    v_mov_b32 v119, 1
    ds_add_rtn_u32 v119, v118, v119
    s_waitcnt lgkmcnt(0)
    v_readfirstlane_b32 s6, v119
    s_mov_b64 exec, -1
    s_cmp_lg_u32 s6, 7
    s_cbranch_scc1 L_qk_wait
    s_setprio 3
    v_mov_b32 v118, 131096
    s_mov_b32 s7, 3200000
LW_37:
    ds_read_b32 v119, v118
    s_waitcnt lgkmcnt(0)
    v_readfirstlane_b32 s6, v119
    s_nop 0
    s_cmp_ge_u32 s6, 1
    s_cbranch_scc1 LWD_38
    s_sleep 1
    s_sub_u32 s7, s7, 1
    s_cmp_lg_u32 s7, 0
    s_cbranch_scc1 LW_37
LWD_38:
    v_and_b32 v2, 7, v0
    v_lshlrev_b32 v2, 3, v2
    v_add_u32 v3, 131584, v2
    ds_read_b64 v[10:11], v3
    s_waitcnt lgkmcnt(0)
    v_mov_b32 v12, v10
    s_nop 1
    v_max_f32_dpp v12, v12, v12 row_ror:4 row_mask:0xf bank_mask:0xf
    s_nop 1
    v_max_f32_dpp v12, v12, v12 row_ror:2 row_mask:0xf bank_mask:0xf
    s_nop 1
    v_max_f32_dpp v12, v12, v12 row_ror:1 row_mask:0xf bank_mask:0xf
    s_mov_b32 s6, 1069066811
    v_sub_f32 v13, v10, v12
    v_mul_f32 v13, s6, v13
    v_exp_f32 v13, v13
    s_nop 0
    v_mul_f32 v11, v11, v13
    s_nop 1
    v_add_f32_dpp v11, v11, v11 row_ror:4 row_mask:0xf bank_mask:0xf
    s_nop 1
    v_add_f32_dpp v11, v11, v11 row_ror:2 row_mask:0xf bank_mask:0xf
    s_nop 1
    v_add_f32_dpp v11, v11, v11 row_ror:1 row_mask:0xf bank_mask:0xf
    s_nop 0
    v_readfirstlane_b32 s64, v12
    v_readfirstlane_b32 s65, v11
    s_lshl_b32 s6, s10, 3
    s_add_u32 s6, s6, 28672
    s_nop 3
    s_atomic_swap_x2 s[64:65], s[16:17], s6
    s_lshl_b32 s12, s4, 6
    s_add_u32 s12, s12, 28672
    s_waitcnt lgkmcnt(0)
    s_mov_b32 s7, 400000
SP_39:
    s_load_dwordx16 s[64:79], s[16:17], s12 glc
    s_waitcnt lgkmcnt(0)
    s_max_u32 s6, s64, s65
    s_max_u32 s6, s6, s66
    s_max_u32 s6, s6, s67
    s_max_u32 s6, s6, s68
    s_max_u32 s6, s6, s69
    s_max_u32 s6, s6, s70
    s_max_u32 s6, s6, s71
    s_max_u32 s6, s6, s72
    s_max_u32 s6, s6, s73
    s_max_u32 s6, s6, s74
    s_max_u32 s6, s6, s75
    s_max_u32 s6, s6, s76
    s_max_u32 s6, s6, s77
    s_max_u32 s6, s6, s78
    s_max_u32 s6, s6, s79
    s_cmp_lg_u32 s6, -1
    s_cbranch_scc1 SPD_40
    s_sub_u32 s7, s7, 1
    s_cmp_lg_u32 s7, 0
    s_cbranch_scc1 SP_39
SPD_40:
    v_mov_b32 v12, s64
    v_max_f32 v12, s66, v12
    v_max_f32 v12, s68, v12
    v_max_f32 v12, s70, v12
    v_max_f32 v12, s72, v12
    v_max_f32 v12, s74, v12
    v_max_f32 v12, s76, v12
    v_max_f32 v12, s78, v12
    s_mov_b32 s6, 1069066811
    v_sub_f32 v20, s64, v12
    v_sub_f32 v21, s66, v12
    v_sub_f32 v22, s68, v12
    v_sub_f32 v23, s70, v12
    v_sub_f32 v24, s72, v12
    v_sub_f32 v25, s74, v12
    v_sub_f32 v26, s76, v12
    v_sub_f32 v27, s78, v12
    v_mul_f32 v20, s6, v20
    v_mul_f32 v21, s6, v21
    v_mul_f32 v22, s6, v22
    v_mul_f32 v23, s6, v23
    v_mul_f32 v24, s6, v24
    v_mul_f32 v25, s6, v25
    v_mul_f32 v26, s6, v26
    v_mul_f32 v27, s6, v27
    v_exp_f32 v20, v20
    v_exp_f32 v21, v21
    v_exp_f32 v22, v22
    v_exp_f32 v23, v23
    v_exp_f32 v24, v24
    v_exp_f32 v25, v25
    v_exp_f32 v26, v26
    v_exp_f32 v27, v27
    s_nop 0
    v_mul_f32 v11, s65, v20
    v_fma_f32 v11, s67, v21, v11
    v_fma_f32 v11, s69, v22, v11
    v_fma_f32 v11, s71, v23, v11
    v_fma_f32 v11, s73, v24, v11
    v_fma_f32 v11, s75, v25, v11
    v_fma_f32 v11, s77, v26, v11
    v_fma_f32 v11, s79, v27, v11
    v_mov_b32 v14, 1.0
    v_rcp_f32 v15, v11
    s_nop 0
    v_fma_f32 v16, -v11, v15, 1.0
    v_fma_f32 v15, v16, v15, v15
    v_mul_f32 v16, v14, v15
    v_fma_f32 v13, -v11, v16, v14
    v_fma_f32 v13, v13, v15, v16
    v_mov_b32 v3, 131136
    s_mov_b64 exec, 1
    ds_write_b64 v3, v[12:13]
    s_mov_b64 exec, -1
    s_waitcnt lgkmcnt(0)
    v_mov_b32 v118, 131084
    v_mov_b32 v119, 1
    ds_write_b32 v118, v119
L_qk_wait:
    s_setprio 0
    s_sub_u32 s15, s2, 1
    s_cmp_lt_u32 s15, 80
    s_cbranch_scc1 L_wwob
    s_branch L_wdoneb
L_wwob:
    s_mul_i32 s11, s15, 6554
    s_lshr_b32 s11, s11, 16
    s_mul_i32 s6, s11, 10
    s_sub_u32 s12, s15, s6
    s_mov_b32 s20, s44
    s_and_b32 s21, s45, 0xffff
    s_mov_b32 s22, 5242880
    s_mov_b32 s23, 0x20000
    v_lshrrev_b32 v2, 3, v0
    v_mul_u32_u24 v2, 1280, v2
    v_and_b32 v3, 7, v0
    v_lshlrev_b32 v3, 4, v3
    v_add_u32 v2, v2, v3
    s_lshl_b32 s14, s11, 3
    s_add_u32 s14, s14, s3
    s_mul_i32 s8, s14, 81920
    s_lshl_b32 s13, s12, 7
    s_add_u32 s8, s8, s13
    v_mov_b32 v118, 131228
    s_mov_b32 s7, 3200000
LW_41:
    ds_read_b32 v119, v118
    s_waitcnt lgkmcnt(0)
    v_readfirstlane_b32 s6, v119
    s_nop 0
    s_cmp_ge_u32 s6, 1
    s_cbranch_scc1 LWD_42
    s_sleep 2
    s_sub_u32 s7, s7, 1
    s_cmp_lg_u32 s7, 0
    s_cbranch_scc1 LW_41
LWD_42:
    buffer_load_dwordx4 v[48:51], v2, s[20:23], s8 offen nt
    s_waitcnt vmcnt(2)
    s_add_u32 s8, s8, 10240
    buffer_load_dwordx4 v[52:55], v2, s[20:23], s8 offen nt
    s_waitcnt vmcnt(2)
    s_add_u32 s8, s8, 10240
    buffer_load_dwordx4 v[56:59], v2, s[20:23], s8 offen nt
    s_waitcnt vmcnt(2)
    s_add_u32 s8, s8, 10240
    buffer_load_dwordx4 v[60:63], v2, s[20:23], s8 offen nt
    s_waitcnt vmcnt(2)
    s_add_u32 s8, s8, 10240
    buffer_load_dwordx4 v[64:67], v2, s[20:23], s8 offen nt
    s_waitcnt vmcnt(2)
    s_add_u32 s8, s8, 10240
    buffer_load_dwordx4 v[68:71], v2, s[20:23], s8 offen nt
    s_waitcnt vmcnt(2)
    s_add_u32 s8, s8, 10240
    buffer_load_dwordx4 v[72:75], v2, s[20:23], s8 offen nt
    s_waitcnt vmcnt(2)
    s_add_u32 s8, s8, 10240
    buffer_load_dwordx4 v[76:79], v2, s[20:23], s8 offen nt
    s_waitcnt vmcnt(2)
L_wdoneb:
L_tail:
    s_cmp_lt_u32 s15, 80
    s_cbranch_scc1 L_wo
    s_cmp_ge_u32 s2, 202
    s_cbranch_scc1 L_ffn
    s_branch L_end
L_vwave:
    s_cmp_eq_u32 s3, 15
    s_cbranch_scc1 L_kload
    s_cmp_lg_u32 s3, 10
    s_cbranch_scc1 L_nopt
    s_mov_b64 exec, 1
    v_mov_b32 v2, s9
    global_load_dword v3, v2, s[40:41] nt
    s_lshl_b32 s6, s2, 7
    s_add_u32 s6, s6, 0x100000
    v_mov_b32 v2, s6
    global_load_dword v4, v2, s[16:17] nt
    s_mov_b64 exec, 7
    v_lshlrev_b32 v2, 21, v0
    s_lshl_b32 s6, s2, 7
    v_add_u32 v2, s6, v2
    global_load_dword v5, v2, s[44:45] nt
    s_mov_b64 exec, 3
    global_load_dword v6, v2, s[48:49] nt
    global_load_dword v7, v2, s[50:51] nt
    s_mov_b64 exec, -1
L_nopt:
    s_cmp_lg_u32 s3, 8
    s_cbranch_scc1 L_vw2
    s_sub_u32 s11, s2, 81
    s_cmp_lt_u32 s11, 64
    s_cbranch_scc1 L_flags
L_vw2:
    s_cmp_lg_u32 s35, 0
    s_cbranch_scc1 BO_43
    s_barrier
    s_mov_b32 s35, 1
BO_43:
    s_setprio 1
    s_mov_b32 s20, s40
    s_and_b32 s21, s41, 0xffff
    s_mov_b32 s22, 134217728
    s_mov_b32 s23, 0x20000
    s_sub_u32 s11, s3, 8
    s_lshl_b32 s6, s11, 14
    s_add_u32 s8, s9, s6
    v_lshlrev_b32 v2, 4, v0
    s_lshl_b32 s6, s11, 2
    s_add_u32 s12, s6, 131200
    s_add_u32 s13, s6, 131104
    v_mov_b32 v118, s12
    s_mov_b32 s7, 3200000
LW_44:
    ds_read_b32 v119, v118
    s_waitcnt lgkmcnt(0)
    v_readfirstlane_b32 s6, v119
    s_nop 0
    s_cmp_ge_u32 s6, 1
    s_cbranch_scc1 LWD_45
    s_sleep 2
    s_sub_u32 s7, s7, 1
    s_cmp_lg_u32 s7, 0
    s_cbranch_scc1 LW_44
LWD_45:
    buffer_load_dwordx4 v[48:51], v2, s[20:23], s8 offen offset:0 nt
    buffer_load_dwordx4 v[52:55], v2, s[20:23], s8 offen offset:1024 nt
    buffer_load_dwordx4 v[56:59], v2, s[20:23], s8 offen offset:2048 nt
    buffer_load_dwordx4 v[60:63], v2, s[20:23], s8 offen offset:3072 nt
    s_add_u32 s8, s8, 4096
    buffer_load_dwordx4 v[64:67], v2, s[20:23], s8 offen offset:0 nt
    buffer_load_dwordx4 v[68:71], v2, s[20:23], s8 offen offset:1024 nt
    buffer_load_dwordx4 v[72:75], v2, s[20:23], s8 offen offset:2048 nt
    buffer_load_dwordx4 v[76:79], v2, s[20:23], s8 offen offset:3072 nt
    s_add_u32 s8, s8, 4096
    buffer_load_dwordx4 v[80:83], v2, s[20:23], s8 offen offset:0 nt
    buffer_load_dwordx4 v[84:87], v2, s[20:23], s8 offen offset:1024 nt
    buffer_load_dwordx4 v[88:91], v2, s[20:23], s8 offen offset:2048 nt
    buffer_load_dwordx4 v[92:95], v2, s[20:23], s8 offen offset:3072 nt
    s_add_u32 s8, s8, 4096
    buffer_load_dwordx4 v[96:99], v2, s[20:23], s8 offen offset:0 nt
    buffer_load_dwordx4 v[100:103], v2, s[20:23], s8 offen offset:1024 nt
    buffer_load_dwordx4 v[104:107], v2, s[20:23], s8 offen offset:2048 nt
    buffer_load_dwordx4 v[108:111], v2, s[20:23], s8 offen offset:3072 nt
    v_mov_b32 v117, 1
    s_sub_u32 s12, s2, 81
    s_cmp_lt_u32 s12, 64
    s_cbranch_scc1 L_v_q
    s_cmp_ge_u32 s11, 6
    s_cbranch_scc1 L_v_late
    s_waitcnt vmcnt(0)
    ds_write_b32 v118, v117 offset:8
    s_branch L_v_late
L_v_q:
    s_cmp_ge_u32 s11, 5
    s_cbranch_scc1 L_v_late
    s_waitcnt vmcnt(0)
    ds_write_b32 v118, v117 offset:12
L_v_late:
    s_lshl_b32 s14, s11, 8
    s_add_u32 s14, s14, 132096
    v_lshrrev_b32 v3, 4, v0
    v_lshlrev_b32 v3, 6, v3
    v_add_u32 v3, s14, v3
    v_lshlrev_b32 v7, 2, v0
    v_add_u32 v7, s14, v7
    v_and_b32 v4, 15, v0
    v_lshlrev_b32 v4, 5, v4
    v_lshrrev_b32 v5, 4, v0
    v_lshl_add_u32 v4, v5, 4, v4
    s_lshl_b32 s14, s11, 9
    s_add_u32 s14, s14, 140288
    v_add_u32 v4, s14, v4
    v_and_b32 v5, 15, v0
    v_and_b32 v6, 1, v5
    v_lshlrev_b32 v6, 4, v6
    v_mov_b32 v39, 0xffff
    v_lshlrev_b32 v6, v6, v39
    v_lshrrev_b32 v5, 1, v5
    v_cmp_eq_u32 vcc, 0, v5
    s_nop 1
    v_cndmask_b32 v36, 0, v6, vcc
    v_cmp_eq_u32 vcc, 1, v5
    s_nop 1
    v_cndmask_b32 v37, 0, v6, vcc
    v_cmp_eq_u32 vcc, 2, v5
    s_nop 1
    v_cndmask_b32 v38, 0, v6, vcc
    v_cmp_eq_u32 vcc, 3, v5
    s_nop 1
    v_cndmask_b32 v39, 0, v6, vcc
    v_mov_b32 v5, 131136
    s_mov_b64 s[96:97], -1
DRY_46:
    s_cmp_eq_u32 s96, 0
    s_cbranch_scc1 SK_47
    v_mov_b32 v118, 131084
    s_mov_b32 s7, 3200000
LW_48:
    ds_read_b32 v119, v118
    s_waitcnt lgkmcnt(0)
    v_readfirstlane_b32 s6, v119
    s_nop 0
    s_cmp_ge_u32 s6, 1
    s_cbranch_scc1 LWD_49
    s_sleep 1
    s_sub_u32 s7, s7, 1
    s_cmp_lg_u32 s7, 0
    s_cbranch_scc1 LW_48
LWD_49:
SK_47:
    ds_read_b64 v[10:11], v5
    ds_read_b32 v9, v7
    s_mov_b32 s6, 1069066811
    s_waitcnt lgkmcnt(0)
    v_sub_f32 v9, v9, v10
    v_mul_f32 v9, s6, v9
    v_exp_f32 v9, v9
    s_nop 0
    v_mul_f32 v9, v9, v11
    v_cvt_pk_bf16_f32 v9, v9, v9
    ds_write_b32 v7, v9
    s_waitcnt lgkmcnt(0)
    ds_read_b128 v[20:23], v3 offset:0
    ds_read_b128 v[24:27], v3 offset:16
    ds_read_b128 v[28:31], v3 offset:32
    ds_read_b128 v[32:35], v3 offset:48
    s_waitcnt lgkmcnt(0)
    v_and_b32 v12, v36, v20
    v_and_b32 v13, v37, v20
    v_and_b32 v14, v38, v20
    v_and_b32 v15, v39, v20
    v_and_b32 v16, v36, v21
    v_and_b32 v17, v37, v21
    v_and_b32 v18, v38, v21
    v_and_b32 v19, v39, v21
    s_cbranch_execz WS_50
    s_waitcnt vmcnt(15)
WS_50:
    v_mfma_f32_16x16x32_bf16 v[8:11], v[12:15], v[48:51], 0
    v_and_b32 v12, v36, v22
    v_and_b32 v13, v37, v22
    v_and_b32 v14, v38, v22
    v_and_b32 v15, v39, v22
    s_cbranch_execz WS_51
    s_waitcnt vmcnt(14)
WS_51:
    v_mfma_f32_16x16x32_bf16 v[8:11], v[16:19], v[52:55], v[8:11]
    v_and_b32 v16, v36, v23
    v_and_b32 v17, v37, v23
    v_and_b32 v18, v38, v23
    v_and_b32 v19, v39, v23
    s_cbranch_execz WS_52
    s_waitcnt vmcnt(13)
WS_52:
    v_mfma_f32_16x16x32_bf16 v[8:11], v[12:15], v[56:59], v[8:11]
    v_and_b32 v12, v36, v24
    v_and_b32 v13, v37, v24
    v_and_b32 v14, v38, v24
    v_and_b32 v15, v39, v24
    s_cbranch_execz WS_53
    s_waitcnt vmcnt(12)
WS_53:
    v_mfma_f32_16x16x32_bf16 v[8:11], v[16:19], v[60:63], v[8:11]
    v_and_b32 v16, v36, v25
    v_and_b32 v17, v37, v25
    v_and_b32 v18, v38, v25
    v_and_b32 v19, v39, v25
    s_cbranch_execz WS_54
    s_waitcnt vmcnt(11)
WS_54:
    v_mfma_f32_16x16x32_bf16 v[8:11], v[12:15], v[64:67], v[8:11]
    v_and_b32 v12, v36, v26
    v_and_b32 v13, v37, v26
    v_and_b32 v14, v38, v26
    v_and_b32 v15, v39, v26
    s_cbranch_execz WS_55
    s_waitcnt vmcnt(10)
WS_55:
    v_mfma_f32_16x16x32_bf16 v[8:11], v[16:19], v[68:71], v[8:11]
    v_and_b32 v16, v36, v27
    v_and_b32 v17, v37, v27
    v_and_b32 v18, v38, v27
    v_and_b32 v19, v39, v27
    s_cbranch_execz WS_56
    s_waitcnt vmcnt(9)
WS_56:
    v_mfma_f32_16x16x32_bf16 v[8:11], v[12:15], v[72:75], v[8:11]
    v_and_b32 v12, v36, v28
    v_and_b32 v13, v37, v28
    v_and_b32 v14, v38, v28
    v_and_b32 v15, v39, v28
    s_cbranch_execz WS_57
    s_waitcnt vmcnt(8)
WS_57:
    v_mfma_f32_16x16x32_bf16 v[8:11], v[16:19], v[76:79], v[8:11]
    v_and_b32 v16, v36, v29
    v_and_b32 v17, v37, v29
    v_and_b32 v18, v38, v29
    v_and_b32 v19, v39, v29
    s_cbranch_execz WS_58
    s_waitcnt vmcnt(7)
WS_58:
    v_mfma_f32_16x16x32_bf16 v[8:11], v[12:15], v[80:83], v[8:11]
    v_and_b32 v12, v36, v30
    v_and_b32 v13, v37, v30
    v_and_b32 v14, v38, v30
    v_and_b32 v15, v39, v30
    s_cbranch_execz WS_59
    s_waitcnt vmcnt(6)
WS_59:
    v_mfma_f32_16x16x32_bf16 v[8:11], v[16:19], v[84:87], v[8:11]
    v_and_b32 v16, v36, v31
    v_and_b32 v17, v37, v31
    v_and_b32 v18, v38, v31
    v_and_b32 v19, v39, v31
    s_cbranch_execz WS_60
    s_waitcnt vmcnt(5)
WS_60:
    v_mfma_f32_16x16x32_bf16 v[8:11], v[12:15], v[88:91], v[8:11]
    v_and_b32 v12, v36, v32
    v_and_b32 v13, v37, v32
    v_and_b32 v14, v38, v32
    v_and_b32 v15, v39, v32
    s_cbranch_execz WS_61
    s_waitcnt vmcnt(4)
WS_61:
    v_mfma_f32_16x16x32_bf16 v[8:11], v[16:19], v[92:95], v[8:11]
    v_and_b32 v16, v36, v33
    v_and_b32 v17, v37, v33
    v_and_b32 v18, v38, v33
    v_and_b32 v19, v39, v33
    s_cbranch_execz WS_62
    s_waitcnt vmcnt(3)
WS_62:
    v_mfma_f32_16x16x32_bf16 v[8:11], v[12:15], v[96:99], v[8:11]
    v_and_b32 v12, v36, v34
    v_and_b32 v13, v37, v34
    v_and_b32 v14, v38, v34
    v_and_b32 v15, v39, v34
    s_cbranch_execz WS_63
    s_waitcnt vmcnt(2)
WS_63:
    v_mfma_f32_16x16x32_bf16 v[8:11], v[16:19], v[100:103], v[8:11]
    v_and_b32 v16, v36, v35
    v_and_b32 v17, v37, v35
    v_and_b32 v18, v38, v35
    v_and_b32 v19, v39, v35
    s_cbranch_execz WS_64
    s_waitcnt vmcnt(1)
WS_64:
    v_mfma_f32_16x16x32_bf16 v[8:11], v[12:15], v[104:107], v[8:11]
    s_nop 1
    s_cbranch_execz WS_65
    s_waitcnt vmcnt(0)
WS_65:
    v_mfma_f32_16x16x32_bf16 v[8:11], v[16:19], v[108:111], v[8:11]
    s_nop 7
    s_cmp_lg_u32 s96, 0
    s_cbranch_scc1 DRE_66
    s_mov_b64 s[96:97], -1
    s_mov_b64 exec, -1
    s_branch DRY_46
DRE_66:
    s_mov_b32 exec_lo, -1
    s_mov_b32 exec_hi, 0
    ds_write_b128 v4, v[8:11]
    s_mov_b64 exec, -1
    s_mov_b64 exec, 1
    s_waitcnt lgkmcnt(0)
    v_mov_b32 v118, 131088
    v_mov_b32 v119, 1
    ds_add_rtn_u32 v119, v118, v119
    s_waitcnt lgkmcnt(0)
    v_readfirstlane_b32 s6, v119
    s_mov_b64 exec, -1
    s_cmp_lg_u32 s6, 7
    s_cbranch_scc1 L_end
    v_lshlrev_b32 v2, 3, v0
    v_add_u32 v3, 140288, v2
    ds_read_b64 v[20:21], v3 offset:0
    ds_read_b64 v[22:23], v3 offset:512
    ds_read_b64 v[24:25], v3 offset:1024
    ds_read_b64 v[26:27], v3 offset:1536
    ds_read_b64 v[28:29], v3 offset:2048
    ds_read_b64 v[30:31], v3 offset:2560
    ds_read_b64 v[32:33], v3 offset:3072
    ds_read_b64 v[34:35], v3 offset:3584
    s_lshl_b32 s6, s10, 9
    s_add_u32 s6, s6, 71680
    v_add_u32 v2, s6, v2
    s_waitcnt lgkmcnt(0)
    v_add_f32 v20, v20, v22
    v_add_f32 v21, v21, v23
    v_add_f32 v20, v20, v24
    v_add_f32 v21, v21, v25
    v_add_f32 v20, v20, v26
    v_add_f32 v21, v21, v27
    v_add_f32 v20, v20, v28
    v_add_f32 v21, v21, v29
    v_add_f32 v20, v20, v30
    v_add_f32 v21, v21, v31
    v_add_f32 v20, v20, v32
    v_add_f32 v21, v21, v33
    v_add_f32 v20, v20, v34
    v_add_f32 v21, v21, v35
    global_store_dwordx2 v2, v[20:21], s[16:17] sc1
    s_waitcnt lgkmcnt(0)
    v_mov_b32 v118, 131156
    v_mov_b32 v119, 1
    ds_write_b32 v118, v119
    s_branch L_end
L_wo:
    v_and_b32 v3, 7, v0
    v_and_b32 v4, 1, v3
    v_lshlrev_b32 v4, 4, v4
    v_mov_b32 v43, 0xffff
    v_lshlrev_b32 v4, v4, v43
    v_lshrrev_b32 v3, 1, v3
    v_cmp_eq_u32 vcc, 0, v3
    s_nop 1
    v_cndmask_b32 v40, 0, v4, vcc
    v_cmp_eq_u32 vcc, 1, v3
    s_nop 1
    v_cndmask_b32 v41, 0, v4, vcc
    v_cmp_eq_u32 vcc, 2, v3
    s_nop 1
    v_cndmask_b32 v42, 0, v4, vcc
    v_cmp_eq_u32 vcc, 3, v3
    s_nop 1
    v_cndmask_b32 v43, 0, v4, vcc
    s_lshr_b32 s8, s14, 1
    s_lshl_b32 s8, s8, 12
    s_and_b32 s13, s14, 1
    s_lshl_b32 s13, s13, 8
    s_add_u32 s8, s8, s13
    s_add_u32 s8, s8, 71680
    v_lshlrev_b32 v2, 2, v0
    v_add_u32 v2, s8, v2
    v_lshrrev_b32 v3, 3, v0
    v_lshlrev_b32 v3, 2, v3
    v_and_b32 v7, 7, v0
    v_lshlrev_b32 v7, 5, v7
    v_bfe_u32 v17, v0, 4, 1
    v_lshl_add_u32 v7, v17, 4, v7
    v_lshrrev_b32 v17, 5, v0
    v_lshl_add_u32 v7, v17, 8, v7
    s_lshl_b32 s6, s3, 9
    v_add_u32 v7, s6, v7
    v_lshlrev_b32 v44, 2, v0
    s_mul_i32 s6, s11, 2560
    s_lshl_b32 s8, s12, 8
    s_add_u32 s6, s6, s8
    s_add_u32 s6, s6, 340992
    v_add_u32 v45, s6, v44
    s_mov_b64 s[96:97], -1
DRY_67:
    s_cmp_eq_u32 s96, 0
    s_cbranch_scc1 SK_68
    v_mov_b32 v118, 131156
    s_mov_b32 s7, 3200000
LW_69:
    ds_read_b32 v119, v118
    s_waitcnt lgkmcnt(0)
    v_readfirstlane_b32 s6, v119
    s_nop 0
    s_cmp_ge_u32 s6, 1
    s_cbranch_scc1 LWD_70
    s_sleep 2
    s_sub_u32 s7, s7, 1
    s_cmp_lg_u32 s7, 0
    s_cbranch_scc1 LW_69
LWD_70:
    s_setprio 3
    s_mov_b32 s7, 400000
GP_71:
    global_load_dword v20, v2, s[16:17] offset:0 sc1
    global_load_dword v21, v2, s[16:17] offset:512 sc1
    global_load_dword v22, v2, s[16:17] offset:1024 sc1
    global_load_dword v23, v2, s[16:17] offset:1536 sc1
    global_load_dword v24, v2, s[16:17] offset:2048 sc1
    global_load_dword v25, v2, s[16:17] offset:2560 sc1
    global_load_dword v26, v2, s[16:17] offset:3072 sc1
    global_load_dword v27, v2, s[16:17] offset:3584 sc1
    s_waitcnt vmcnt(0)
    v_max_u32 v11, v20, v21
    v_max3_u32 v11, v11, v22, v23
    v_max3_u32 v11, v11, v24, v25
    v_max3_u32 v11, v11, v26, v27
    v_cmp_eq_u32 vcc, -1, v11
    s_nop 0
    s_cbranch_vccz GPD_72
    s_sub_u32 s7, s7, 1
    s_cmp_lg_u32 s7, 0
    s_cbranch_scc1 GP_71
GPD_72:
SK_68:
    v_add_f32 v20, v20, v21
    v_add_f32 v22, v22, v23
    v_add_f32 v24, v24, v25
    v_add_f32 v26, v26, v27
    v_add_f32 v20, v20, v22
    v_add_f32 v24, v24, v26
    v_add_f32 v20, v20, v24
    v_cvt_pk_bf16_f32 v20, v20, v20
    ds_bpermute_b32 v28, v3, v20 offset:0
    ds_bpermute_b32 v29, v3, v20 offset:32
    ds_bpermute_b32 v30, v3, v20 offset:64
    ds_bpermute_b32 v31, v3, v20 offset:96
    ds_bpermute_b32 v32, v3, v20 offset:128
    ds_bpermute_b32 v33, v3, v20 offset:160
    ds_bpermute_b32 v34, v3, v20 offset:192
    ds_bpermute_b32 v35, v3, v20 offset:224
    s_waitcnt lgkmcnt(0)
    v_and_b32 v12, v40, v28
    v_and_b32 v13, v41, v28
    v_and_b32 v14, v42, v28
    v_and_b32 v15, v43, v28
    v_and_b32 v16, v40, v29
    v_and_b32 v17, v41, v29
    v_and_b32 v18, v42, v29
    v_and_b32 v19, v43, v29
    v_mfma_f32_16x16x32_bf16 v[8:11], v[12:15], v[48:51], 0
    v_and_b32 v12, v40, v30
    v_and_b32 v13, v41, v30
    v_and_b32 v14, v42, v30
    v_and_b32 v15, v43, v30
    v_mfma_f32_16x16x32_bf16 v[8:11], v[16:19], v[52:55], v[8:11]
    v_and_b32 v16, v40, v31
    v_and_b32 v17, v41, v31
    v_and_b32 v18, v42, v31
    v_and_b32 v19, v43, v31
    v_mfma_f32_16x16x32_bf16 v[8:11], v[12:15], v[56:59], v[8:11]
    v_and_b32 v12, v40, v32
    v_and_b32 v13, v41, v32
    v_and_b32 v14, v42, v32
    v_and_b32 v15, v43, v32
    v_mfma_f32_16x16x32_bf16 v[8:11], v[16:19], v[60:63], v[8:11]
    v_and_b32 v16, v40, v33
    v_and_b32 v17, v41, v33
    v_and_b32 v18, v42, v33
    v_and_b32 v19, v43, v33
    v_mfma_f32_16x16x32_bf16 v[8:11], v[12:15], v[64:67], v[8:11]
    v_and_b32 v12, v40, v34
    v_and_b32 v13, v41, v34
    v_and_b32 v14, v42, v34
    v_and_b32 v15, v43, v34
    v_mfma_f32_16x16x32_bf16 v[8:11], v[16:19], v[68:71], v[8:11]
    v_and_b32 v16, v40, v35
    v_and_b32 v17, v41, v35
    v_and_b32 v18, v42, v35
    v_and_b32 v19, v43, v35
    v_mfma_f32_16x16x32_bf16 v[8:11], v[12:15], v[72:75], v[8:11]
    s_nop 1
    v_mfma_f32_16x16x32_bf16 v[8:11], v[16:19], v[76:79], v[8:11]
    s_nop 7
    s_and_b32 exec_lo, s96, 0x00ff00ff
    s_and_b32 exec_hi, s97, 0xff00ff00
    ds_write_b128 v7, v[8:11]
    s_mov_b64 exec, s[96:97]
    s_waitcnt lgkmcnt(0)
    s_cmp_eq_u32 s96, 0
    s_cbranch_scc1 SK_73
    s_barrier
    s_cmp_lg_u32 s3, 0
    s_cbranch_scc1 L_end
SK_73:
    ds_read_b32 v48, v44 offset:0
    ds_read_b32 v49, v44 offset:256
    ds_read_b32 v50, v44 offset:512
    ds_read_b32 v51, v44 offset:768
    ds_read_b32 v52, v44 offset:1024
    ds_read_b32 v53, v44 offset:1280
    ds_read_b32 v54, v44 offset:1536
    ds_read_b32 v55, v44 offset:1792
    ds_read_b32 v56, v44 offset:2048
    ds_read_b32 v57, v44 offset:2304
    ds_read_b32 v58, v44 offset:2560
    ds_read_b32 v59, v44 offset:2816
    ds_read_b32 v60, v44 offset:3072
    ds_read_b32 v61, v44 offset:3328
    ds_read_b32 v62, v44 offset:3584
    ds_read_b32 v63, v44 offset:3840
    s_waitcnt lgkmcnt(0)
    v_add_f32 v48, v48, v49
    v_add_f32 v50, v50, v51
    v_add_f32 v52, v52, v53
    v_add_f32 v54, v54, v55
    v_add_f32 v56, v56, v57
    v_add_f32 v58, v58, v59
    v_add_f32 v60, v60, v61
    v_add_f32 v62, v62, v63
    v_add_f32 v48, v48, v50
    v_add_f32 v52, v52, v54
    v_add_f32 v56, v56, v58
    v_add_f32 v60, v60, v62
    v_add_f32 v48, v48, v52
    v_add_f32 v56, v56, v60
    v_add_f32 v48, v48, v56
    s_cmp_lg_u32 s96, 0
    s_cbranch_scc1 DRE_74
    s_mov_b64 s[96:97], -1
    s_mov_b64 exec, -1
    s_branch DRY_67
DRE_74:
    global_store_dword v45, v48, s[16:17] sc1
    s_branch L_end
L_ffn:
    s_sub_u32 s11, s2, 202
    s_sub_u32 s12, s3, 1
    s_cmp_ge_u32 s12, 5
    s_cbranch_scc1 L_ffn0
    s_setprio 3
    s_mov_b32 s28, s36
    s_and_b32 s29, s37, 0xffff
    s_mov_b32 s30, 1280
    s_mov_b32 s31, 0x20000
    s_lshl_b32 s6, s12, 8
    v_lshlrev_b32 v2, 2, v0
    buffer_load_dword v104, v2, s[28:31], s6 offen
    s_load_dword s33, s[36:37], 0
    s_lshl_b32 s6, s12, 9
    v_lshlrev_b32 v2, 3, v0
    v_add_u32 v2, s6, v2
    v_add_u32 v4, 30720, v2
    v_add_u32 v5, 40960, v2
    v_add_u32 v6, 51200, v2
    v_add_u32 v7, 61440, v2
    v_add_u32 v8, 5120, v4
    v_add_u32 v9, 5120, v5
    v_add_u32 v10, 5120, v6
    v_add_u32 v11, 5120, v7
    s_mov_b32 s7, 400000
GP_75:
    global_load_dwordx2 v[14:15], v4, s[16:17] offset:0 sc1
    global_load_dwordx2 v[16:17], v5, s[16:17] offset:0 sc1
    global_load_dwordx2 v[18:19], v6, s[16:17] offset:0 sc1
    global_load_dwordx2 v[20:21], v7, s[16:17] offset:0 sc1
    global_load_dwordx2 v[22:23], v4, s[16:17] offset:2560 sc1
    global_load_dwordx2 v[24:25], v5, s[16:17] offset:2560 sc1
    global_load_dwordx2 v[26:27], v6, s[16:17] offset:2560 sc1
    global_load_dwordx2 v[28:29], v7, s[16:17] offset:2560 sc1
    global_load_dwordx2 v[30:31], v8, s[16:17] sc1
    global_load_dwordx2 v[32:33], v9, s[16:17] sc1
    global_load_dwordx2 v[34:35], v10, s[16:17] sc1
    global_load_dwordx2 v[36:37], v11, s[16:17] sc1
    s_waitcnt vmcnt(0)
    v_max_u32 v12, v14, v15
    v_max3_u32 v12, v12, v16, v17
    v_max3_u32 v12, v12, v18, v19
    v_max3_u32 v12, v12, v20, v21
    v_max3_u32 v12, v12, v22, v23
    v_max3_u32 v12, v12, v24, v25
    v_max3_u32 v12, v12, v26, v27
    v_max3_u32 v12, v12, v28, v29
    v_max3_u32 v12, v12, v30, v31
    v_max3_u32 v12, v12, v32, v33
    v_max3_u32 v12, v12, v34, v35
    v_max3_u32 v12, v12, v36, v37
    v_cmp_eq_u32 vcc, -1, v12
    s_nop 0
    s_cbranch_vccz GPD_76
    s_sleep 1
    s_sub_u32 s7, s7, 1
    s_cmp_lg_u32 s7, 0
    s_cbranch_scc1 GP_75
GPD_76:
    v_add_f32 v106, v14, v16
    v_add_f32 v106, v106, v18
    v_add_f32 v106, v106, v20
    v_cvt_pk_bf16_f32 v106, v106, v106
    v_and_b32 v106, 0xffff0000, v106
    v_add_f32 v107, v15, v17
    v_add_f32 v107, v107, v19
    v_add_f32 v107, v107, v21
    v_cvt_pk_bf16_f32 v107, v107, v107
    v_and_b32 v107, 0xffff0000, v107
    v_add_f32 v108, v22, v24
    v_add_f32 v108, v108, v26
    v_add_f32 v108, v108, v28
    v_cvt_pk_bf16_f32 v108, v108, v108
    v_and_b32 v108, 0xffff0000, v108
    v_add_f32 v109, v23, v25
    v_add_f32 v109, v109, v27
    v_add_f32 v109, v109, v29
    v_cvt_pk_bf16_f32 v109, v109, v109
    v_and_b32 v109, 0xffff0000, v109
    v_add_f32 v110, v30, v32
    v_add_f32 v110, v110, v34
    v_add_f32 v110, v110, v36
    v_cvt_pk_bf16_f32 v110, v110, v110
    v_and_b32 v110, 0xffff0000, v110
    v_add_f32 v111, v31, v33
    v_add_f32 v111, v111, v35
    v_add_f32 v111, v111, v37
    v_cvt_pk_bf16_f32 v111, v111, v111
    v_and_b32 v111, 0xffff0000, v111
    v_add_f32 v110, 1.0, v110
    v_cvt_pk_bf16_f32 v110, v110, v110
    v_and_b32 v110, 0xffff0000, v110
    v_add_f32 v111, 1.0, v111
    v_cvt_pk_bf16_f32 v111, v111, v111
    v_and_b32 v111, 0xffff0000, v111
    v_and_b32 v105, 0xffff0000, v104
    v_lshlrev_b32 v104, 16, v104
    v_add_u32 v112, 340992, v2
    v_add_u32 v114, 8192, v2
    s_waitcnt lgkmcnt(0)
    s_lshl_b32 s33, s33, 16
    v_mov_b32 v118, 131228
    s_mov_b32 s7, 3200000
LW_77:
    ds_read_b32 v119, v118
    s_waitcnt lgkmcnt(0)
    v_readfirstlane_b32 s6, v119
    s_nop 0
    s_cmp_ge_u32 s6, 1
    s_cbranch_scc1 LWD_78
    s_sleep 2
    s_sub_u32 s7, s7, 1
    s_cmp_lg_u32 s7, 0
    s_cbranch_scc1 LW_77
LWD_78:
    s_setprio 0
    s_mov_b32 s20, s48
    s_and_b32 s21, s49, 0xffff
    s_mov_b32 s22, 2211840
    s_mov_b32 s23, 0x20000
    s_mov_b32 s24, s50
    s_and_b32 s25, s51, 0xffff
    s_mov_b32 s26, 2211840
    s_mov_b32 s27, 0x20000
    v_lshrrev_b32 v2, 2, v0
    v_mul_u32_u24 v2, 3456, v2
    v_and_b32 v3, 3, v0
    v_lshlrev_b32 v3, 4, v3
    v_add_u32 v2, v2, v3
    s_mul_i32 s8, s3, 276480
    s_lshl_b32 s6, s11, 6
    s_add_u32 s8, s8, s6
    buffer_load_dwordx4 v[40:43], v2, s[20:23], s8 offen nt
    s_waitcnt vmcnt(1)
    s_add_u32 s8, s8, 55296
    buffer_load_dwordx4 v[44:47], v2, s[20:23], s8 offen nt
    s_waitcnt vmcnt(1)
    s_add_u32 s8, s8, 55296
    buffer_load_dwordx4 v[48:51], v2, s[20:23], s8 offen nt
    s_waitcnt vmcnt(1)
    s_add_u32 s8, s8, 55296
    buffer_load_dwordx4 v[52:55], v2, s[20:23], s8 offen nt
    s_waitcnt vmcnt(1)
    s_add_u32 s8, s8, 55296
    buffer_load_dwordx4 v[56:59], v2, s[20:23], s8 offen nt
    s_waitcnt vmcnt(1)
    s_cmp_ge_u32 s12, 5
    s_cbranch_scc1 L_now2
    v_lshrrev_b32 v2, 4, v0
    v_mul_u32_u24 v2, 1280, v2
    v_and_b32 v3, 15, v0
    v_lshlrev_b32 v3, 4, v3
    v_add_u32 v2, v2, v3
    s_mul_i32 s8, s11, 40960
    s_lshl_b32 s6, s12, 8
    s_add_u32 s8, s8, s6
    buffer_load_dwordx4 v[72:75], v2, s[24:27], s8 offen nt
    s_waitcnt vmcnt(5)
    s_add_u32 s8, s8, 5120
    buffer_load_dwordx4 v[76:79], v2, s[24:27], s8 offen nt
    s_waitcnt vmcnt(5)
    s_add_u32 s8, s8, 5120
    buffer_load_dwordx4 v[80:83], v2, s[24:27], s8 offen nt
    s_waitcnt vmcnt(5)
    s_add_u32 s8, s8, 5120
    buffer_load_dwordx4 v[84:87], v2, s[24:27], s8 offen nt
    s_waitcnt vmcnt(5)
    s_add_u32 s8, s8, 5120
    buffer_load_dwordx4 v[88:91], v2, s[24:27], s8 offen nt
    s_waitcnt vmcnt(5)
    s_add_u32 s8, s8, 5120
    buffer_load_dwordx4 v[92:95], v2, s[24:27], s8 offen nt
    s_waitcnt vmcnt(5)
    s_add_u32 s8, s8, 5120
    buffer_load_dwordx4 v[96:99], v2, s[24:27], s8 offen nt
    s_waitcnt vmcnt(5)
    s_add_u32 s8, s8, 5120
    buffer_load_dwordx4 v[100:103], v2, s[24:27], s8 offen nt
    s_waitcnt vmcnt(5)
L_now2:
    v_mov_b32 v118, 131156
    s_mov_b32 s7, 3200000
LW_79:
    ds_read_b32 v119, v118
    s_waitcnt lgkmcnt(0)
    v_readfirstlane_b32 s6, v119
    s_nop 0
    s_cmp_ge_u32 s6, 1
    s_cbranch_scc1 LWD_80
    s_sleep 2
    s_sub_u32 s7, s7, 1
    s_cmp_lg_u32 s7, 0
    s_cbranch_scc1 LW_79
LWD_80:
    s_setprio 3
    s_lshl_b32 s6, s12, 7
    v_lshlrev_b32 v2, 1, v0
    v_add_u32 v2, s6, v2
    v_mul_u32_u24 v3, 3277, v2
    v_lshrrev_b32 v3, 18, v3
    v_mul_u32_u24 v4, 80, v3
    v_sub_u32 v2, v2, v4
    v_lshlrev_b32 v115, 9, v3
    v_bfe_u32 v3, v2, 2, 2
    v_lshl_add_u32 v115, v3, 7, v115
    v_lshrrev_b32 v3, 4, v2
    v_lshl_add_u32 v115, v3, 3, v115
    v_bfe_u32 v3, v2, 1, 1
    v_lshl_add_u32 v115, v3, 2, v115
    v_add_u32 v115, 20480, v115
    s_lshl_b32 s6, s3, 9
    s_add_u32 s6, s6, 20480
    v_lshrrev_b32 v2, 3, v0
    v_lshlrev_b32 v2, 6, v2
    v_add_u32 v2, s6, v2
    v_bfe_u32 v4, v0, 2, 2
    v_lshlrev_b32 v4, 7, v4
    v_and_b32 v3, 3, v0
    v_lshl_add_u32 v4, v3, 5, v4
    v_bfe_u32 v3, v0, 4, 1
    v_lshl_add_u32 v4, v3, 4, v4
    s_lshl_b32 s6, s3, 9
    s_add_u32 s6, s6, 12288
    v_add_u32 v4, s6, v4
    v_and_b32 v3, 7, v0
    v_and_b32 v8, 1, v3
    v_lshlrev_b32 v8, 4, v8
    v_mov_b32 v63, 0xffff
    v_lshlrev_b32 v8, v8, v63
    v_lshrrev_b32 v3, 1, v3
    v_cmp_eq_u32 vcc, 0, v3
    s_nop 1
    v_cndmask_b32 v60, 0, v8, vcc
    v_cmp_eq_u32 vcc, 1, v3
    s_nop 1
    v_cndmask_b32 v61, 0, v8, vcc
    v_cmp_eq_u32 vcc, 2, v3
    s_nop 1
    v_cndmask_b32 v62, 0, v8, vcc
    v_cmp_eq_u32 vcc, 3, v3
    s_nop 1
    v_cndmask_b32 v63, 0, v8, vcc
    s_mov_b32 s14, 0xff00ff00
    s_mov_b32 s15, 0xff00ff00
    v_and_b32 v5, 7, v0
    v_lshlrev_b32 v5, 4, v5
    v_lshrrev_b32 v3, 4, v0
    v_lshl_add_u32 v5, v3, 2, v5
    v_bfe_u32 v3, v0, 3, 1
    v_lshl_add_u32 v5, v3, 11, v5
    v_add_u32 v5, 12288, v5
    v_lshrrev_b32 v6, 4, v0
    v_lshlrev_b32 v6, 2, v6
    v_and_b32 v7, 15, v0
    v_lshlrev_b32 v7, 5, v7
    v_lshrrev_b32 v3, 4, v0
    v_lshl_add_u32 v7, v3, 4, v7
    s_mul_i32 s6, s11, 2560
    s_lshl_b32 s8, s12, 9
    s_add_u32 s6, s6, s8
    s_add_u32 s6, s6, 202752
    v_add_u32 v7, s6, v7
    v_add_u32 v121, 5120, v112
    v_add_u32 v122, 10240, v112
    v_add_u32 v123, 15360, v112
    s_lshl_b32 s6, s12, 3
    s_add_u32 s6, s6, 16384
    v_mov_b32 v113, s6
    v_mov_b32 v116, 16384
    v_and_b32 v3, 15, v0
    v_and_b32 v8, 1, v3
    v_lshlrev_b32 v8, 4, v8
    v_mov_b32 v120, 0xffff
    v_lshlrev_b32 v8, v8, v120
    v_lshrrev_b32 v3, 1, v3
    v_cmp_eq_u32 vcc, 0, v3
    s_nop 1
    v_cndmask_b32 v117, 0, v8, vcc
    v_cmp_eq_u32 vcc, 1, v3
    s_nop 1
    v_cndmask_b32 v118, 0, v8, vcc
    v_cmp_eq_u32 vcc, 2, v3
    s_nop 1
    v_cndmask_b32 v119, 0, v8, vcc
    v_cmp_eq_u32 vcc, 3, v3
    s_nop 1
    v_cndmask_b32 v120, 0, v8, vcc
    s_waitcnt vmcnt(0)
    s_mov_b64 s[96:97], -1
DRY_81:
    s_cmp_eq_u32 s96, 0
    s_cbranch_scc1 SK_82
    s_mov_b32 s7, 400000
GP_83:
    global_load_dwordx2 v[8:9], v112, s[16:17] offset:0 sc1
    global_load_dwordx2 v[10:11], v112, s[16:17] offset:2560 sc1
    global_load_dwordx2 v[12:13], v121, s[16:17] offset:0 sc1
    global_load_dwordx2 v[14:15], v121, s[16:17] offset:2560 sc1
    global_load_dwordx2 v[16:17], v122, s[16:17] offset:0 sc1
    global_load_dwordx2 v[18:19], v122, s[16:17] offset:2560 sc1
    global_load_dwordx2 v[20:21], v123, s[16:17] offset:0 sc1
    global_load_dwordx2 v[22:23], v123, s[16:17] offset:2560 sc1
    s_waitcnt vmcnt(0)
    v_max_u32 v3, v8, v9
    v_max3_u32 v3, v3, v10, v11
    v_max3_u32 v3, v3, v12, v13
    v_max3_u32 v3, v3, v14, v15
    v_max3_u32 v3, v3, v16, v17
    v_max3_u32 v3, v3, v18, v19
    v_max3_u32 v3, v3, v20, v21
    v_max3_u32 v3, v3, v22, v23
    v_cmp_eq_u32 vcc, -1, v3
    s_nop 0
    s_cbranch_vccz GPD_84
    s_sub_u32 s7, s7, 1
    s_cmp_lg_u32 s7, 0
    s_cbranch_scc1 GP_83
GPD_84:
SK_82:
    v_add_f32 v8, v8, v10
    v_add_f32 v9, v9, v11
    v_add_f32 v12, v12, v14
    v_add_f32 v13, v13, v15
    v_add_f32 v16, v16, v18
    v_add_f32 v17, v17, v19
    v_add_f32 v20, v20, v22
    v_add_f32 v21, v21, v23
    v_add_f32 v8, v8, v12
    v_add_f32 v9, v9, v13
    v_add_f32 v16, v16, v20
    v_add_f32 v17, v17, v21
    v_add_f32 v8, v8, v16
    v_add_f32 v9, v9, v17
    v_cvt_pk_bf16_f32 v22, v8, v9
    v_lshlrev_b32 v20, 16, v22
    v_and_b32 v21, 0xffff0000, v22
    v_mul_f32 v20, v106, v20
    v_mul_f32 v21, v107, v21
    v_cvt_pk_bf16_f32 v22, v20, v21
    v_lshlrev_b32 v20, 16, v22
    v_and_b32 v21, 0xffff0000, v22
    v_add_f32 v104, v104, v20
    v_add_f32 v105, v105, v21
    v_cvt_pk_bf16_f32 v22, v104, v105
    v_lshlrev_b32 v104, 16, v22
    v_and_b32 v105, 0xffff0000, v22
    v_subrev_f32 v20, s33, v104
    v_subrev_f32 v21, s33, v105
    v_mul_f32 v23, v20, v20
    v_add_f32 v22, v20, v21
    v_fmac_f32 v23, v21, v21
    ds_write_b64 v114, v[104:105]
    v_add_f32_dpp v22, v22, v22 row_ror:8 row_mask:0xf bank_mask:0xf
    v_add_f32_dpp v23, v23, v23 row_ror:8 row_mask:0xf bank_mask:0xf
    s_nop 0
    v_add_f32_dpp v22, v22, v22 row_ror:4 row_mask:0xf bank_mask:0xf
    v_add_f32_dpp v23, v23, v23 row_ror:4 row_mask:0xf bank_mask:0xf
    s_nop 0
    v_add_f32_dpp v22, v22, v22 row_ror:2 row_mask:0xf bank_mask:0xf
    v_add_f32_dpp v23, v23, v23 row_ror:2 row_mask:0xf bank_mask:0xf
    s_nop 0
    v_add_f32_dpp v22, v22, v22 row_ror:1 row_mask:0xf bank_mask:0xf
    v_add_f32_dpp v23, v23, v23 row_ror:1 row_mask:0xf bank_mask:0xf
    v_mov_b32 v24, v22
    v_mov_b32 v25, v23
    s_nop 0
    v_permlane16_swap_b32 v22, v24
    v_permlane16_swap_b32 v23, v25
    v_add_f32 v22, v22, v24
    v_add_f32 v23, v23, v25
    v_mov_b32 v24, v22
    v_mov_b32 v25, v23
    s_nop 0
    v_permlane32_swap_b32 v22, v24
    v_permlane32_swap_b32 v23, v25
    v_add_f32 v22, v22, v24
    v_add_f32 v23, v23, v25
    s_and_b32 exec_lo, s96, 1
    s_and_b32 exec_hi, s97, 0
    ds_write_b64 v113, v[22:23]
    s_mov_b64 exec, s[96:97]
    s_waitcnt lgkmcnt(0)
    s_cmp_eq_u32 s96, 0
    s_cbranch_scc1 SK_85
    s_barrier
SK_85:
    ds_read_b128 v[20:23], v116
    ds_read_b128 v[24:27], v116 offset:16
    ds_read_b64 v[28:29], v116 offset:32
    s_waitcnt lgkmcnt(0)
    v_add_f32 v20, v20, v22
    v_add_f32 v21, v21, v23
    v_add_f32 v24, v24, v26
    v_add_f32 v25, v25, v27
    v_add_f32 v20, v20, v28
    v_add_f32 v21, v21, v29
    v_add_f32 v20, v20, v24
    v_add_f32 v21, v21, v25
    v_mul_f32 v30, 0x3acccccd, v20
    v_fma_f32 v31, -v20, v30, v21
    v_add_f32 v30, s33, v30
    v_mul_f32 v31, 0x3acccccd, v31
    v_cvt_pk_bf16_f32 v32, v30, v31
    v_lshlrev_b32 v30, 16, v32
    v_and_b32 v31, 0xffff0000, v32
    v_add_f32 v31, 0x3727c5ac, v31
    v_sub_f32 v20, v104, v30
    v_sub_f32 v21, v105, v30
    v_cvt_pk_bf16_f32 v31, v31, v31
    v_and_b32 v31, 0xffff0000, v31
    v_cvt_pk_bf16_f32 v22, v20, v21
    v_lshlrev_b32 v20, 16, v22
    v_and_b32 v21, 0xffff0000, v22
    v_sqrt_f32 v32, v31
    s_nop 0
    v_rcp_f32 v33, v32
    v_fma_f32 v31, -v32, v32, v31
    v_mul_f32 v33, 0.5, v33
    v_fma_f32 v31, v31, v33, v32
    v_cvt_pk_bf16_f32 v31, v31, v31
    v_and_b32 v31, 0xffff0000, v31
    v_rcp_f32 v32, v31
    s_nop 0
    v_mul_f32 v22, v20, v32
    v_mul_f32 v23, v21, v32
    v_fma_f32 v20, -v31, v22, v20
    v_fma_f32 v21, -v31, v23, v21
    v_fma_f32 v20, v20, v32, v22
    v_fma_f32 v21, v21, v32, v23
    v_cvt_pk_bf16_f32 v22, v20, v21
    v_lshlrev_b32 v20, 16, v22
    v_and_b32 v21, 0xffff0000, v22
    v_mul_f32 v20, v20, v110
    v_mul_f32 v21, v21, v111
    v_cvt_pk_bf16_f32 v22, v20, v21
    v_lshlrev_b32 v20, 16, v22
    v_and_b32 v21, 0xffff0000, v22
    v_add_f32 v20, v20, v108
    v_add_f32 v21, v21, v109
    v_cvt_pk_bf16_f32 v20, v20, v20
    v_cvt_pk_bf16_f32 v21, v21, v21
    ds_write_b32 v115, v20
    ds_write_b32 v115, v21 offset:64
    s_waitcnt lgkmcnt(0)
    s_barrier
    ds_read_b128 v[24:27], v2
    ds_read_b128 v[28:31], v2 offset:16
    ds_read_b64 v[32:33], v2 offset:32
    s_waitcnt lgkmcnt(0)
    v_and_b32 v16, v60, v24
    v_and_b32 v17, v61, v24
    v_and_b32 v18, v62, v24
    v_and_b32 v19, v63, v24
    v_and_b32 v20, v60, v25
    v_and_b32 v21, v61, v25
    v_and_b32 v22, v62, v25
    v_and_b32 v23, v63, v25
    v_mfma_f32_16x16x32_bf16 v[8:11], v[16:19], v[40:43], 0
    v_and_b32 v16, v60, v26
    v_and_b32 v17, v61, v26
    v_and_b32 v18, v62, v26
    v_and_b32 v19, v63, v26
    v_mfma_f32_16x16x32_bf16 v[12:15], v[20:23], v[40:43], 0
    v_and_b32 v20, v60, v27
    v_and_b32 v21, v61, v27
    v_and_b32 v22, v62, v27
    v_and_b32 v23, v63, v27
    v_mfma_f32_16x16x32_bf16 v[8:11], v[16:19], v[44:47], v[8:11]
    v_and_b32 v16, v60, v28
    v_and_b32 v17, v61, v28
    v_and_b32 v18, v62, v28
    v_and_b32 v19, v63, v28
    v_mfma_f32_16x16x32_bf16 v[12:15], v[20:23], v[44:47], v[12:15]
    v_and_b32 v20, v60, v29
    v_and_b32 v21, v61, v29
    v_and_b32 v22, v62, v29
    v_and_b32 v23, v63, v29
    v_mfma_f32_16x16x32_bf16 v[8:11], v[16:19], v[48:51], v[8:11]
    v_and_b32 v16, v60, v30
    v_and_b32 v17, v61, v30
    v_and_b32 v18, v62, v30
    v_and_b32 v19, v63, v30
    v_mfma_f32_16x16x32_bf16 v[12:15], v[20:23], v[48:51], v[12:15]
    v_and_b32 v20, v60, v31
    v_and_b32 v21, v61, v31
    v_and_b32 v22, v62, v31
    v_and_b32 v23, v63, v31
    v_mfma_f32_16x16x32_bf16 v[8:11], v[16:19], v[52:55], v[8:11]
    v_and_b32 v16, v60, v32
    v_and_b32 v17, v61, v32
    v_and_b32 v18, v62, v32
    v_and_b32 v19, v63, v32
    v_mfma_f32_16x16x32_bf16 v[12:15], v[20:23], v[52:55], v[12:15]
    v_and_b32 v20, v60, v33
    v_and_b32 v21, v61, v33
    v_and_b32 v22, v62, v33
    v_and_b32 v23, v63, v33
    v_mfma_f32_16x16x32_bf16 v[8:11], v[16:19], v[56:59], v[8:11]
    s_nop 1
    v_mfma_f32_16x16x32_bf16 v[12:15], v[20:23], v[56:59], v[12:15]
    s_nop 7
    v_cndmask_b32 v8, v8, v12, s[14:15]
    v_cndmask_b32 v9, v9, v13, s[14:15]
    v_cndmask_b32 v10, v10, v14, s[14:15]
    v_cndmask_b32 v11, v11, v15, s[14:15]
    s_mov_b32 exec_lo, 0x0f0f0f0f
    s_mov_b32 exec_hi, 0xf0f0f0f0
    ds_write_b128 v4, v[8:11]
    s_mov_b64 exec, -1
    s_waitcnt lgkmcnt(0)
    s_barrier
    ds_read_b32 v20, v5 offset:0
    ds_read_b32 v21, v5 offset:128
    ds_read_b32 v22, v5 offset:256
    ds_read_b32 v23, v5 offset:384
    ds_read_b32 v24, v5 offset:512
    ds_read_b32 v25, v5 offset:640
    ds_read_b32 v26, v5 offset:768
    ds_read_b32 v27, v5 offset:896
    ds_read_b32 v28, v5 offset:1024
    ds_read_b32 v29, v5 offset:1152
    ds_read_b32 v30, v5 offset:1280
    ds_read_b32 v31, v5 offset:1408
    ds_read_b32 v32, v5 offset:1536
    ds_read_b32 v33, v5 offset:1664
    ds_read_b32 v34, v5 offset:1792
    ds_read_b32 v35, v5 offset:1920
    s_waitcnt lgkmcnt(0)
    v_add_f32 v20, v20, v21
    v_add_f32 v22, v22, v23
    v_add_f32 v24, v24, v25
    v_add_f32 v26, v26, v27
    v_add_f32 v28, v28, v29
    v_add_f32 v30, v30, v31
    v_add_f32 v32, v32, v33
    v_add_f32 v34, v34, v35
    v_add_f32 v20, v20, v22
    v_add_f32 v24, v24, v26
    v_add_f32 v28, v28, v30
    v_add_f32 v32, v32, v34
    v_add_f32 v20, v20, v24
    v_add_f32 v28, v28, v32
    v_add_f32 v20, v20, v28
    s_nop 1
    v_add_f32_dpp v20, v20, v20 row_ror:8 row_mask:0xf bank_mask:0xf
    v_max_f32 v20, 0, v20
    v_cvt_pk_bf16_f32 v20, v20, v20
    s_nop 1
    v_and_b32_dpp v12, v20, v117 row_newbcast:0 row_mask:0xf bank_mask:0xf
    v_and_b32_dpp v13, v20, v118 row_newbcast:0 row_mask:0xf bank_mask:0xf
    v_and_b32_dpp v14, v20, v119 row_newbcast:0 row_mask:0xf bank_mask:0xf
    v_and_b32_dpp v15, v20, v120 row_newbcast:0 row_mask:0xf bank_mask:0xf
    v_and_b32_dpp v16, v20, v117 row_newbcast:1 row_mask:0xf bank_mask:0xf
    v_and_b32_dpp v17, v20, v118 row_newbcast:1 row_mask:0xf bank_mask:0xf
    v_and_b32_dpp v18, v20, v119 row_newbcast:1 row_mask:0xf bank_mask:0xf
    v_and_b32_dpp v19, v20, v120 row_newbcast:1 row_mask:0xf bank_mask:0xf
    v_mfma_f32_16x16x32_bf16 v[8:11], v[12:15], v[72:75], 0
    v_and_b32_dpp v12, v20, v117 row_newbcast:2 row_mask:0xf bank_mask:0xf
    v_and_b32_dpp v13, v20, v118 row_newbcast:2 row_mask:0xf bank_mask:0xf
    v_and_b32_dpp v14, v20, v119 row_newbcast:2 row_mask:0xf bank_mask:0xf
    v_and_b32_dpp v15, v20, v120 row_newbcast:2 row_mask:0xf bank_mask:0xf
    v_mfma_f32_16x16x32_bf16 v[8:11], v[16:19], v[76:79], v[8:11]
    v_and_b32_dpp v16, v20, v117 row_newbcast:3 row_mask:0xf bank_mask:0xf
    v_and_b32_dpp v17, v20, v118 row_newbcast:3 row_mask:0xf bank_mask:0xf
    v_and_b32_dpp v18, v20, v119 row_newbcast:3 row_mask:0xf bank_mask:0xf
    v_and_b32_dpp v19, v20, v120 row_newbcast:3 row_mask:0xf bank_mask:0xf
    v_mfma_f32_16x16x32_bf16 v[8:11], v[12:15], v[80:83], v[8:11]
    v_and_b32_dpp v12, v20, v117 row_newbcast:4 row_mask:0xf bank_mask:0xf
    v_and_b32_dpp v13, v20, v118 row_newbcast:4 row_mask:0xf bank_mask:0xf
    v_and_b32_dpp v14, v20, v119 row_newbcast:4 row_mask:0xf bank_mask:0xf
    v_and_b32_dpp v15, v20, v120 row_newbcast:4 row_mask:0xf bank_mask:0xf
    v_mfma_f32_16x16x32_bf16 v[8:11], v[16:19], v[84:87], v[8:11]
    v_and_b32_dpp v16, v20, v117 row_newbcast:5 row_mask:0xf bank_mask:0xf
    v_and_b32_dpp v17, v20, v118 row_newbcast:5 row_mask:0xf bank_mask:0xf
    v_and_b32_dpp v18, v20, v119 row_newbcast:5 row_mask:0xf bank_mask:0xf
    v_and_b32_dpp v19, v20, v120 row_newbcast:5 row_mask:0xf bank_mask:0xf
    v_mfma_f32_16x16x32_bf16 v[8:11], v[12:15], v[88:91], v[8:11]
    v_and_b32_dpp v12, v20, v117 row_newbcast:6 row_mask:0xf bank_mask:0xf
    v_and_b32_dpp v13, v20, v118 row_newbcast:6 row_mask:0xf bank_mask:0xf
    v_and_b32_dpp v14, v20, v119 row_newbcast:6 row_mask:0xf bank_mask:0xf
    v_and_b32_dpp v15, v20, v120 row_newbcast:6 row_mask:0xf bank_mask:0xf
    v_mfma_f32_16x16x32_bf16 v[8:11], v[16:19], v[92:95], v[8:11]
    v_and_b32_dpp v16, v20, v117 row_newbcast:7 row_mask:0xf bank_mask:0xf
    v_and_b32_dpp v17, v20, v118 row_newbcast:7 row_mask:0xf bank_mask:0xf
    v_and_b32_dpp v18, v20, v119 row_newbcast:7 row_mask:0xf bank_mask:0xf
    v_and_b32_dpp v19, v20, v120 row_newbcast:7 row_mask:0xf bank_mask:0xf
    v_mfma_f32_16x16x32_bf16 v[8:11], v[12:15], v[96:99], v[8:11]
    s_nop 1
    v_mfma_f32_16x16x32_bf16 v[8:11], v[16:19], v[100:103], v[8:11]
    s_nop 7
    s_cmp_lg_u32 s96, 0
    s_cbranch_scc1 DRE_86
    s_mov_b64 s[96:97], -1
    s_mov_b64 exec, -1
    s_branch DRY_81
DRE_86:
    s_mov_b32 exec_lo, -1
    s_mov_b32 exec_hi, 0
    global_store_dwordx4 v7, v[8:11], s[16:17] sc1
    s_mov_b64 exec, -1
    s_branch L_end
L_ffn0:
    s_cmp_lg_u32 s3, 0
    s_cbranch_scc1 L_nored
    s_cmp_ge_u32 s11, 40
    s_cbranch_scc1 L_nored
    v_and_b32 v100, 3, v0
    v_lshlrev_b32 v100, 2, v100
    v_lshrrev_b32 v3, 4, v0
    v_add_u32 v100, v100, v3
    s_lshl_b32 s6, s11, 4
    v_add_u32 v100, s6, v100
    v_lshlrev_b32 v3, 2, v100
    v_add_u32 v4, 38400, v3
    v_add_u32 v5, 48640, v3
    v_add_u32 v6, 58880, v3
    v_add_u32 v7, 69120, v3
    s_mov_b32 s7, 400000
GP_87:
    global_load_dword v14, v4, s[16:17] sc1
    global_load_dword v15, v5, s[16:17] sc1
    global_load_dword v16, v6, s[16:17] sc1
    global_load_dword v17, v7, s[16:17] sc1
    s_waitcnt vmcnt(0)
    v_max_u32 v9, v14, v15
    v_max3_u32 v9, v9, v16, v17
    v_cmp_eq_u32 vcc, -1, v9
    s_nop 0
    s_cbranch_vccz GPD_88
    s_sleep 1
    s_sub_u32 s7, s7, 1
    s_cmp_lg_u32 s7, 0
    s_cbranch_scc1 GP_87
GPD_88:
    v_add_f32 v101, v14, v15
    v_add_f32 v101, v101, v16
    v_add_f32 v101, v101, v17
    v_cvt_pk_bf16_f32 v101, v101, v101
    v_and_b32 v101, 0xffff0000, v101
    v_add_u32 v103, 8192, v3
    v_lshrrev_b32 v2, 2, v0
    v_mul_u32_u24 v2, 2560, v2
    v_and_b32 v3, 3, v0
    v_lshl_add_u32 v2, v3, 4, v2
    s_lshl_b32 s6, s11, 6
    s_add_u32 s6, s6, 202752
    v_add_u32 v67, s6, v2
    v_add_u32 v68, 40960, v67
    v_add_u32 v69, 81920, v67
    v_add_u32 v70, 122880, v67
    v_mov_b32 v84, 0
    v_mov_b32 v85, 0
    v_mov_b32 v86, 0
    v_mov_b32 v87, 0
    v_lshlrev_b32 v71, 1, v100
L_nored:
    v_mov_b32 v118, 131228
    s_mov_b32 s7, 3200000
LW_89:
    ds_read_b32 v119, v118
    s_waitcnt lgkmcnt(0)
    v_readfirstlane_b32 s6, v119
    s_nop 0
    s_cmp_ge_u32 s6, 1
    s_cbranch_scc1 LWD_90
    s_sleep 2
    s_sub_u32 s7, s7, 1
    s_cmp_lg_u32 s7, 0
    s_cbranch_scc1 LW_89
LWD_90:
    s_mov_b32 s20, s48
    s_and_b32 s21, s49, 0xffff
    s_mov_b32 s22, 2211840
    s_mov_b32 s23, 0x20000
    s_mov_b32 s24, s50
    s_and_b32 s25, s51, 0xffff
    s_mov_b32 s26, 2211840
    s_mov_b32 s27, 0x20000
    v_lshrrev_b32 v2, 2, v0
    v_mul_u32_u24 v2, 3456, v2
    v_and_b32 v3, 3, v0
    v_lshlrev_b32 v3, 4, v3
    v_add_u32 v2, v2, v3
    s_mul_i32 s8, s3, 276480
    s_lshl_b32 s6, s11, 6
    s_add_u32 s8, s8, s6
    buffer_load_dwordx4 v[40:43], v2, s[20:23], s8 offen nt
    s_waitcnt vmcnt(1)
    s_add_u32 s8, s8, 55296
    buffer_load_dwordx4 v[44:47], v2, s[20:23], s8 offen nt
    s_waitcnt vmcnt(1)
    s_add_u32 s8, s8, 55296
    buffer_load_dwordx4 v[48:51], v2, s[20:23], s8 offen nt
    s_waitcnt vmcnt(1)
    s_add_u32 s8, s8, 55296
    buffer_load_dwordx4 v[52:55], v2, s[20:23], s8 offen nt
    s_waitcnt vmcnt(1)
    s_add_u32 s8, s8, 55296
    buffer_load_dwordx4 v[56:59], v2, s[20:23], s8 offen nt
    s_waitcnt vmcnt(1)
    s_cmp_ge_u32 s12, 5
    s_cbranch_scc1 L_now2h
    v_lshrrev_b32 v2, 4, v0
    v_mul_u32_u24 v2, 1280, v2
    v_and_b32 v3, 15, v0
    v_lshlrev_b32 v3, 4, v3
    v_add_u32 v2, v2, v3
    s_mul_i32 s8, s11, 40960
    s_lshl_b32 s6, s12, 8
    s_add_u32 s8, s8, s6
    buffer_load_dwordx4 v[72:75], v2, s[24:27], s8 offen nt
    s_waitcnt vmcnt(5)
    s_add_u32 s8, s8, 5120
    buffer_load_dwordx4 v[76:79], v2, s[24:27], s8 offen nt
    s_waitcnt vmcnt(5)
    s_add_u32 s8, s8, 5120
    buffer_load_dwordx4 v[80:83], v2, s[24:27], s8 offen nt
    s_waitcnt vmcnt(5)
    s_add_u32 s8, s8, 5120
    buffer_load_dwordx4 v[84:87], v2, s[24:27], s8 offen nt
    s_waitcnt vmcnt(5)
    s_add_u32 s8, s8, 5120
    buffer_load_dwordx4 v[88:91], v2, s[24:27], s8 offen nt
    s_waitcnt vmcnt(5)
    s_add_u32 s8, s8, 5120
    buffer_load_dwordx4 v[92:95], v2, s[24:27], s8 offen nt
    s_waitcnt vmcnt(5)
    s_add_u32 s8, s8, 5120
    buffer_load_dwordx4 v[96:99], v2, s[24:27], s8 offen nt
    s_waitcnt vmcnt(5)
    s_add_u32 s8, s8, 5120
    buffer_load_dwordx4 v[100:103], v2, s[24:27], s8 offen nt
    s_waitcnt vmcnt(5)
L_now2h:
    s_lshl_b32 s6, s3, 9
    s_add_u32 s6, s6, 20480
    v_lshrrev_b32 v2, 3, v0
    v_lshlrev_b32 v2, 6, v2
    v_add_u32 v2, s6, v2
    v_bfe_u32 v4, v0, 2, 2
    v_lshlrev_b32 v4, 7, v4
    v_and_b32 v3, 3, v0
    v_lshl_add_u32 v4, v3, 5, v4
    v_bfe_u32 v3, v0, 4, 1
    v_lshl_add_u32 v4, v3, 4, v4
    s_lshl_b32 s6, s3, 9
    s_add_u32 s6, s6, 12288
    v_add_u32 v4, s6, v4
    v_and_b32 v3, 7, v0
    v_and_b32 v8, 1, v3
    v_lshlrev_b32 v8, 4, v8
    v_mov_b32 v63, 0xffff
    v_lshlrev_b32 v8, v8, v63
    v_lshrrev_b32 v3, 1, v3
    v_cmp_eq_u32 vcc, 0, v3
    s_nop 1
    v_cndmask_b32 v60, 0, v8, vcc
    v_cmp_eq_u32 vcc, 1, v3
    s_nop 1
    v_cndmask_b32 v61, 0, v8, vcc
    v_cmp_eq_u32 vcc, 2, v3
    s_nop 1
    v_cndmask_b32 v62, 0, v8, vcc
    v_cmp_eq_u32 vcc, 3, v3
    s_nop 1
    v_cndmask_b32 v63, 0, v8, vcc
    s_mov_b32 s14, 0xff00ff00
    s_mov_b32 s15, 0xff00ff00
    s_setprio 3
    s_waitcnt vmcnt(0)
    s_barrier
    s_barrier
    ds_read_b128 v[24:27], v2
    ds_read_b128 v[28:31], v2 offset:16
    ds_read_b64 v[32:33], v2 offset:32
    s_waitcnt lgkmcnt(0)
    v_and_b32 v16, v60, v24
    v_and_b32 v17, v61, v24
    v_and_b32 v18, v62, v24
    v_and_b32 v19, v63, v24
    v_and_b32 v20, v60, v25
    v_and_b32 v21, v61, v25
    v_and_b32 v22, v62, v25
    v_and_b32 v23, v63, v25
    v_mfma_f32_16x16x32_bf16 v[8:11], v[16:19], v[40:43], 0
    v_and_b32 v16, v60, v26
    v_and_b32 v17, v61, v26
    v_and_b32 v18, v62, v26
    v_and_b32 v19, v63, v26
    v_mfma_f32_16x16x32_bf16 v[12:15], v[20:23], v[40:43], 0
    v_and_b32 v20, v60, v27
    v_and_b32 v21, v61, v27
    v_and_b32 v22, v62, v27
    v_and_b32 v23, v63, v27
    v_mfma_f32_16x16x32_bf16 v[8:11], v[16:19], v[44:47], v[8:11]
    v_and_b32 v16, v60, v28
    v_and_b32 v17, v61, v28
    v_and_b32 v18, v62, v28
    v_and_b32 v19, v63, v28
    v_mfma_f32_16x16x32_bf16 v[12:15], v[20:23], v[44:47], v[12:15]
    v_and_b32 v20, v60, v29
    v_and_b32 v21, v61, v29
    v_and_b32 v22, v62, v29
    v_and_b32 v23, v63, v29
    v_mfma_f32_16x16x32_bf16 v[8:11], v[16:19], v[48:51], v[8:11]
    v_and_b32 v16, v60, v30
    v_and_b32 v17, v61, v30
    v_and_b32 v18, v62, v30
    v_and_b32 v19, v63, v30
    v_mfma_f32_16x16x32_bf16 v[12:15], v[20:23], v[48:51], v[12:15]
    v_and_b32 v20, v60, v31
    v_and_b32 v21, v61, v31
    v_and_b32 v22, v62, v31
    v_and_b32 v23, v63, v31
    v_mfma_f32_16x16x32_bf16 v[8:11], v[16:19], v[52:55], v[8:11]
    v_and_b32 v16, v60, v32
    v_and_b32 v17, v61, v32
    v_and_b32 v18, v62, v32
    v_and_b32 v19, v63, v32
    v_mfma_f32_16x16x32_bf16 v[12:15], v[20:23], v[52:55], v[12:15]
    v_and_b32 v20, v60, v33
    v_and_b32 v21, v61, v33
    v_and_b32 v22, v62, v33
    v_and_b32 v23, v63, v33
    v_mfma_f32_16x16x32_bf16 v[8:11], v[16:19], v[56:59], v[8:11]
    s_nop 1
    v_mfma_f32_16x16x32_bf16 v[12:15], v[20:23], v[56:59], v[12:15]
    s_nop 7
    v_cndmask_b32 v8, v8, v12, s[14:15]
    v_cndmask_b32 v9, v9, v13, s[14:15]
    v_cndmask_b32 v10, v10, v14, s[14:15]
    v_cndmask_b32 v11, v11, v15, s[14:15]
    s_mov_b32 exec_lo, 0x0f0f0f0f
    s_mov_b32 exec_hi, 0xf0f0f0f0
    ds_write_b128 v4, v[8:11]
    s_mov_b64 exec, -1
    s_waitcnt lgkmcnt(0)
    s_barrier
    s_cmp_lg_u32 s3, 0
    s_cbranch_scc1 L_end
    s_cmp_ge_u32 s11, 40
    s_cbranch_scc1 L_end
    ds_read_b32 v102, v103
    s_mov_b32 s7, 400000
GP_91:
    global_load_dwordx4 v[72:75], v67, s[16:17] sc1
    global_load_dwordx4 v[76:79], v68, s[16:17] sc1
    global_load_dwordx4 v[80:83], v69, s[16:17] sc1
    s_mov_b64 exec, 0xffffff
    global_load_dwordx4 v[84:87], v70, s[16:17] sc1
    s_mov_b64 exec, -1
    s_waitcnt vmcnt(0)
    v_max_u32 v9, v72, v73
    v_max3_u32 v9, v9, v74, v75
    v_max3_u32 v9, v9, v76, v77
    v_max3_u32 v9, v9, v78, v79
    v_max3_u32 v9, v9, v80, v81
    v_max3_u32 v9, v9, v82, v83
    v_max3_u32 v9, v9, v84, v85
    v_max3_u32 v9, v9, v86, v87
    v_cmp_eq_u32 vcc, -1, v9
    s_nop 0
    s_cbranch_vccz GPD_92
    s_sub_u32 s7, s7, 1
    s_cmp_lg_u32 s7, 0
    s_cbranch_scc1 GP_91
GPD_92:
    v_add_f32 v20, v72, v76
    v_add_f32 v24, v80, v84
    v_add_f32 v21, v73, v77
    v_add_f32 v25, v81, v85
    v_add_f32 v22, v74, v78
    v_add_f32 v26, v82, v86
    v_add_f32 v23, v75, v79
    v_add_f32 v27, v83, v87
    v_add_f32 v20, v20, v24
    v_add_f32 v21, v21, v25
    v_add_f32 v22, v22, v26
    v_add_f32 v23, v23, v27
    s_nop 1
    v_permlane32_swap_b32 v20, v22
    v_permlane32_swap_b32 v21, v23
    v_add_f32 v20, v20, v22
    v_add_f32 v21, v21, v23
    s_nop 1
    v_permlane16_swap_b32 v20, v21
    v_add_f32 v20, v20, v21
    s_nop 1
    v_add_f32_dpp v20, v20, v20 row_ror:8 row_mask:0xf bank_mask:0xf
    s_nop 1
    v_add_f32_dpp v20, v20, v20 row_ror:4 row_mask:0xf bank_mask:0xf
    v_cvt_pk_bf16_f32 v20, v20, v20
    v_and_b32 v20, 0xffff0000, v20
    v_mul_f32 v20, v101, v20
    v_cvt_pk_bf16_f32 v20, v20, v20
    v_and_b32 v20, 0xffff0000, v20
    s_waitcnt lgkmcnt(0)
    v_add_f32 v20, v102, v20
    v_cvt_pk_bf16_f32 v20, v20, v20
    s_mov_b32 exec_lo, 0x000f000f
    s_mov_b32 exec_hi, 0x000f000f
    global_store_short v71, v20, s[56:57]
    s_mov_b64 exec, -1
L_end:
L_end2:
    s_endpgm
.section .rodata,"a"
.p2align 6
.amdhsa_kernel adaLN_cond__sliding_block_cached__dense_activation_relu__decode_kernel
  .amdhsa_next_free_vgpr 128
  .amdhsa_next_free_sgpr 102
  .amdhsa_accum_offset 128
  .amdhsa_group_segment_fixed_size 0
  .amdhsa_kernarg_size 104
  .amdhsa_user_sgpr_count 2
  .amdhsa_user_sgpr_kernarg_segment_ptr 1
  .amdhsa_system_sgpr_workgroup_id_x 1
  .amdhsa_float_denorm_mode_32 3
.end_amdhsa_kernel
```
